```python
import torch

def _softmax(x, axis=-1):
    return torch.softmax(x, dim=axis)
def _gelu(x):
    return torch.nn.functional.gelu(x, approximate="tanh")
def _silu(x):
    return torch.nn.functional.silu(x)
def _sigmoid(x):
    return torch.sigmoid(x)
def _layernorm(x, axis=-1, eps=1e-5):
    m = x.mean(dim=axis, keepdim=True)
    v = x.var(dim=axis, keepdim=True, unbiased=False)
    return (x - m) / torch.sqrt(v + eps)
def _scatter_add(tgt, idx, src, axis=0):
    return tgt.clone().index_add_(axis, idx, src)
def _segment_sum(src, seg, n):
    out = torch.zeros((n,) + src.shape[1:], dtype=src.dtype)
    return out.index_add_(0, seg, src)
def _pad(x, pw):
    flat = tuple(v for pair in reversed(pw) for v in pair)
    return torch.nn.functional.pad(x, flat)

kernel_name = 'sequential_preLN__mha_block__glu_gated_glu__prompt'

def setup_inputs():

    _w = (lambda a: (lambda t: t.to(torch.bfloat16) if t.is_floating_point() else t)(torch.as_tensor(a)))
    def _A_setup():
        B, S, D, H = 1, 2048, 512, 32
        return {
            "x": _w((lambda *s: torch.randn(*s, dtype=torch.bfloat16) * 0.05)(B, S, D)),
            "wqkv": _w((lambda *s: torch.randn(*s, dtype=torch.bfloat16) * 0.05)(D, 3 * D)),
            "wo": _w((lambda *s: torch.randn(*s, dtype=torch.bfloat16) * 0.05)(D, D)),
        }
    _A_in = _A_setup()

    def _B_setup():
        B, S, D, F = 1, 2048, 512, 1376
        return {
            "x": _w((lambda *s: torch.randn(*s, dtype=torch.bfloat16) * 0.05)(B, S, D)),
            "w_gate": _w((lambda *s: torch.randn(*s, dtype=torch.bfloat16) * 0.05)(D, F)),
            "w_up": _w((lambda *s: torch.randn(*s, dtype=torch.bfloat16) * 0.05)(D, F)),
            "w_down": _w((lambda *s: torch.randn(*s, dtype=torch.bfloat16) * 0.05)(F, D)),
        }
    _B_in = _B_setup()

    return {
        "A_x": _A_in["x"],
        "A_wqkv": _A_in["wqkv"],
        "A_wo": _A_in["wo"],
        "B_x": _B_in["x"],
        "B_w_gate": _B_in["w_gate"],
        "B_w_up": _B_in["w_up"],
        "B_w_down": _B_in["w_down"],
    }

def reference(A_x, A_wqkv, A_wo, B_x, B_w_gate, B_w_up, B_w_down):
    def _A_ref(x, wqkv, wo):
        B, S, D = x.shape
        H = 32
        Dh = D // H
        qkv = (lambda x, *d: x.permute(*d))((x @ wqkv).reshape(B, S, 3, H, Dh), 2, 0, 3, 1, 4)
        q, k, v = qkv[0], qkv[1], qkv[2]
        scores = torch.einsum("bhqd,bhkd->bhqk", q, k) * (Dh ** -0.5)
        p = _softmax(scores, axis=-1)
        o = torch.einsum("bhqk,bhkd->bhqd", p, v)
        return (lambda x, *d: x.permute(*d))(o, 0, 2, 1, 3).reshape(B, S, D) @ wo

    def _B_ref(x, w_gate, w_up, w_down):
        g = torch.einsum("bsd,df->bsf", x, w_gate)
        u = torch.einsum("bsd,df->bsf", x, w_up)
        h = _sigmoid(g) * u
        return torch.einsum("bsf,fd->bsd", h, w_down)

    x = A_x
    h = x + _A_ref(_layernorm(x, axis=-1), A_wqkv, A_wo)
    h2 = h + _B_ref(_layernorm(h, axis=-1), B_w_gate, B_w_up, B_w_down)
    return h2
```

```asm
; @launch grid=(256,1,1) block=(512,1,1) lds=163840
.amdgcn_target "amdgcn-amd-amdhsa--gfx950"
.text
.globl sequential_preLN__mha_block__glu_gated_glu__prompt_kernel
.p2align 8
.type sequential_preLN__mha_block__glu_gated_glu__prompt_kernel,@function
sequential_preLN__mha_block__glu_gated_glu__prompt_kernel:
    s_cmp_ge_u32 s2, 256
    s_cbranch_scc1 tail_end
    s_load_dwordx16 s[4:19], s[0:1], 0
    s_load_dwordx2 s[20:21], s[0:1], 72
    v_lshrrev_b32 v7, 6, v0
    v_and_b32 v6, 63, v0
    v_readfirstlane_b32 s32, v7
    v_lshlrev_b32 v1, 4, v6
    s_and_b32 s34, s2, 7
    s_lshr_b32 s35, s2, 3
    s_and_b32 s33, s32, 3
    s_mov_b32 s22, 0x1800000
    s_mov_b32 s23, 0x20000
    s_mov_b32 s27, 0x20000
    s_mov_b32 s31, 0x20000
    s_mov_b32 s26, 2097152
    s_mov_b32 s30, 1572864
    s_cmp_lt_u32 s32, 4
    s_cbranch_scc1 qkv_comp
    v_lshrrev_b32 v7, 3, v6
    v_lshlrev_b32 v8, 10, v7
    v_mul_u32_u24 v10, 3072, v7
    v_lshrrev_b32 v7, 4, v6
    v_and_b32 v5, 7, v6
    v_xor_b32 v7, v7, v5
    v_lshl_add_u32 v8, v7, 4, v8
    v_xor_b32 v9, 0x2040, v8
    v_add_u32 v9, -1024, v9
    v_lshrrev_b32 v7, 2, v6
    v_and_b32 v7, 4, v7
    v_xor_b32 v7, v7, v5
    v_lshl_add_u32 v10, v7, 4, v10
    v_add_u32 v11, 23552, v10
    s_lshl_b32 s41, s35, 16
    s_lshl_b32 s40, s33, 14
    s_add_u32 s41, s41, s40
    s_lshl_b32 s42, s34, 7
    s_mul_i32 s40, s33, 49152
    s_add_u32 s42, s42, s40
    s_add_u32 s50, s41, 1024
    s_add_u32 s51, s42, 1572864
    s_add_u32 s55, s34, s35
    s_and_b32 s55, s55, 7
    s_lshl_b32 s40, s55, 7
    s_add_u32 s41, s41, s40
    s_mul_i32 s40, s55, 196608
    s_add_u32 s42, s42, s40
    s_lshl_b32 s43, s33, 11
    s_add_u32 s44, s43, 65536
    s_add_u32 s45, s44, 98304
    s_waitcnt lgkmcnt(0)
    s_mov_b64 s[24:25], s[4:5]
    s_mov_b64 s[28:29], s[6:7]
    s_mov_b32 m0, s43
    s_add_u32 s43, s43, 8192
    buffer_load_dwordx4 v8, s[24:27], s41 offen lds
    buffer_load_dwordx4 v9, s[24:27], s41 offen offset:1024 lds
    s_add_u32 s41, s41, 128
    s_cmp_eq_u32 s41, s50
    s_cselect_b32 s40, 1024, 0
    s_sub_u32 s41, s41, s40
    s_mov_b32 m0, s44
    s_add_u32 s40, s42, 0
    buffer_load_dwordx4 v10, s[28:31], s40 offen lds
    buffer_load_dwordx4 v11, s[28:31], s40 offen offset:1024 lds
    s_add_u32 m0, m0, 8192
    s_add_u32 s40, s42, 1024
    buffer_load_dwordx4 v10, s[28:31], s40 offen lds
    buffer_load_dwordx4 v11, s[28:31], s40 offen offset:1024 lds
    s_add_u32 m0, m0, 8192
    s_add_u32 s40, s42, 2048
    buffer_load_dwordx4 v10, s[28:31], s40 offen lds
    buffer_load_dwordx4 v11, s[28:31], s40 offen offset:1024 lds
    s_add_u32 s42, s42, 196608
    s_cmp_eq_u32 s42, s51
    s_cselect_b32 s40, 1572864, 0
    s_sub_u32 s42, s42, s40
    s_add_u32 s44, s44, 24576
    s_cmp_eq_u32 s44, s45
    s_cselect_b32 s40, 98304, 0
    s_sub_u32 s44, s44, s40
    s_mov_b32 m0, s43
    s_add_u32 s43, s43, 8192
    buffer_load_dwordx4 v8, s[24:27], s41 offen lds
    buffer_load_dwordx4 v9, s[24:27], s41 offen offset:1024 lds
    s_add_u32 s41, s41, 128
    s_cmp_eq_u32 s41, s50
    s_cselect_b32 s40, 1024, 0
    s_sub_u32 s41, s41, s40
    s_mov_b32 m0, s44
    s_add_u32 s40, s42, 0
    buffer_load_dwordx4 v10, s[28:31], s40 offen lds
    buffer_load_dwordx4 v11, s[28:31], s40 offen offset:1024 lds
    s_add_u32 m0, m0, 8192
    s_add_u32 s40, s42, 1024
    buffer_load_dwordx4 v10, s[28:31], s40 offen lds
    buffer_load_dwordx4 v11, s[28:31], s40 offen offset:1024 lds
    s_add_u32 m0, m0, 8192
    s_add_u32 s40, s42, 2048
    buffer_load_dwordx4 v10, s[28:31], s40 offen lds
    buffer_load_dwordx4 v11, s[28:31], s40 offen offset:1024 lds
    s_add_u32 s42, s42, 196608
    s_cmp_eq_u32 s42, s51
    s_cselect_b32 s40, 1572864, 0
    s_sub_u32 s42, s42, s40
    s_add_u32 s44, s44, 24576
    s_cmp_eq_u32 s44, s45
    s_cselect_b32 s40, 98304, 0
    s_sub_u32 s44, s44, s40
    v_bfe_u32 v7, v6, 2, 2
    v_lshrrev_b32 v5, 5, v6
    v_lshl_add_u32 v5, v5, 3, v7
    v_lshlrev_b32 v12, 7, v5
    v_lshrrev_b32 v7, 1, v7
    v_lshl_add_u32 v12, v7, 6, v12
    v_bfe_u32 v7, v6, 4, 1
    v_and_b32 v5, 3, v6
    v_lshl_add_u32 v7, v7, 2, v5
    v_lshl_add_u32 v12, v7, 3, v12
    s_lshl_b32 s40, s33, 11
    s_add_u32 s40, s40, 65536
    v_add_u32 v12, s40, v12
    v_xor_b32 v13, 64, v12
    v_lshrrev_b32 v7, 2, v6
    v_xor_b32 v7, v7, v6
    v_bfe_u32 v7, v7, 2, 1
    v_add_u32 v7, -1, v7
    v_and_b32 v16, 0x3f803f80, v7
    v_and_b32 v17, 0x3f803f80, v7
    v_and_b32 v18, 0x3f803f80, v7
    v_and_b32 v19, 0x3f803f80, v7
    s_add_u32 s46, s20, 11075584
    s_addc_u32 s47, s21, 0
    s_load_dword s39, s[46:47], 0
    s_lshl_b32 s37, s34, 11
    s_add_u32 s37, s37, 11010048
    s_getreg_b32 s38, hwreg(HW_REG_XCC_ID, 0, 4)
    s_waitcnt lgkmcnt(0)
    s_mul_i32 s39, s39, 0x9e3779b1
    s_add_u32 s39, s39, 0x7f4a7c15
    s_xor_b32 s38, s38, s39
    v_and_b32 v2, 31, v6
    v_lshlrev_b32 v2, 2, v2
    s_mul_i32 s40, s33, 768
    v_add_u32 v2, s40, v2
    v_and_b32 v14, 255, v0
    v_lshlrev_b32 v14, 2, v14
    v_lshlrev_b32 v15, 1, v14
    s_mul_i32 s56, s34, 12288
    s_add_u32 s56, s56, 11091968
    s_mul_i32 s57, s35, 1536
    s_add_u32 s57, s57, s56
    s_mov_b32 s49, 0
    s_mov_b32 m0, s43
    s_mov_b32 s52, s42
    s_add_u32 s53, s42, 1024
    s_add_u32 s54, s42, 2048
    s_waitcnt vmcnt(8)
    s_cmp_ge_u32 s35, 8
    s_cbranch_scc1 qkv_hloop
    ds_read_b64_tr_b16 v[44:45], v12 offset:0
    ds_read_b64_tr_b16 v[46:47], v12 offset:512
    ds_read_b64_tr_b16 v[48:49], v13 offset:0
    ds_read_b64_tr_b16 v[50:51], v13 offset:512
    ds_read_b64_tr_b16 v[52:53], v12 offset:8192
    ds_read_b64_tr_b16 v[54:55], v12 offset:8704
    ds_read_b64_tr_b16 v[56:57], v13 offset:8192
    ds_read_b64_tr_b16 v[58:59], v13 offset:8704
    ds_read_b64_tr_b16 v[60:61], v12 offset:16384
    ds_read_b64_tr_b16 v[62:63], v12 offset:16896
    ds_read_b64_tr_b16 v[64:65], v13 offset:16384
    ds_read_b64_tr_b16 v[66:67], v13 offset:16896
    s_waitcnt lgkmcnt(10)
    v_mfma_f32_16x16x32_bf16 v[20:23], v[16:19], v[44:47], 0
    s_waitcnt lgkmcnt(8)
    v_mfma_f32_16x16x32_bf16 v[24:27], v[16:19], v[48:51], 0
    s_waitcnt lgkmcnt(6)
    v_mfma_f32_16x16x32_bf16 v[28:31], v[16:19], v[52:55], 0
    s_waitcnt lgkmcnt(4)
    v_mfma_f32_16x16x32_bf16 v[32:35], v[16:19], v[56:59], 0
    s_waitcnt lgkmcnt(2)
    v_mfma_f32_16x16x32_bf16 v[36:39], v[16:19], v[60:63], 0
    s_waitcnt lgkmcnt(0)
    v_mfma_f32_16x16x32_bf16 v[40:43], v[16:19], v[64:67], 0
qkv_hloop:
    s_barrier
    buffer_load_dwordx4 v8, s[24:27], s41 offen lds
    buffer_load_dwordx4 v9, s[24:27], s41 offen offset:1024 lds
    s_mov_b32 m0, s44
    s_add_u32 s43, s43, 8192
    s_add_u32 s41, s41, 128
    s_cmp_eq_u32 s41, s50
    s_cselect_b32 s40, 1024, 0
    s_sub_u32 s41, s41, s40
    buffer_load_dwordx4 v10, s[28:31], s52 offen lds
    s_add_u32 s42, s42, 196608
    s_cmp_eq_u32 s42, s51
    s_cselect_b32 s40, 1572864, 0
    s_sub_u32 s42, s42, s40
    buffer_load_dwordx4 v11, s[28:31], s52 offen offset:1024 lds
    s_add_u32 m0, m0, 8192
    s_add_u32 s44, s44, 24576
    s_cmp_eq_u32 s44, s45
    s_cselect_b32 s40, 98304, 0
    s_sub_u32 s44, s44, s40
    buffer_load_dwordx4 v10, s[28:31], s53 offen lds
    buffer_load_dwordx4 v11, s[28:31], s53 offen offset:1024 lds
    s_add_u32 m0, m0, 8192
    s_add_u32 s49, s49, 1
    buffer_load_dwordx4 v10, s[28:31], s54 offen lds
    buffer_load_dwordx4 v11, s[28:31], s54 offen offset:1024 lds
    s_mov_b32 m0, s43
    s_mov_b32 s52, s42
    s_add_u32 s53, s42, 1024
    s_add_u32 s54, s42, 2048
    s_cmp_ge_u32 s35, 8
    s_cbranch_scc1 qkv_nopub
    s_cmp_gt_u32 s49, 3
    s_cbranch_scc1 qkv_nopub
    s_cmp_lg_u32 s49, 1
    s_cbranch_scc1 qkv_pub2
    ds_write_b32 v2, v20 offset:57344
    ds_write_b32 v2, v24 offset:57472
    ds_write_b32 v2, v28 offset:57600
    ds_write_b32 v2, v32 offset:57728
    ds_write_b32 v2, v36 offset:57856
    ds_write_b32 v2, v40 offset:57984
    s_waitcnt vmcnt(8) lgkmcnt(0)
    s_branch qkv_hloop
qkv_pub2:
    s_cmp_lg_u32 s49, 2
    s_cbranch_scc1 qkv_pub3
    ds_read_b32 v20, v14 offset:57344
    ds_read_b32 v22, v14 offset:58112
    ds_read_b32 v24, v14 offset:58880
    ds_read_b32 v26, v14 offset:59648
    v_mov_b32 v21, s39
    s_cmp_lt_u32 s33, 3
    s_cselect_b32 s57, s57, 0x40000000
    s_waitcnt lgkmcnt(0)
    v_add_f32 v20, v20, v22
    v_add_f32 v24, v24, v26
    v_add_f32 v20, v20, v24
    buffer_store_dwordx2 v[20:21], v15, s[20:23], s57 offen sc0 sc1
qkv_pub3:
    s_waitcnt vmcnt(9)
    s_branch qkv_hloop
qkv_nopub:
    s_cmp_lt_u32 s49, 6
    s_waitcnt vmcnt(8)
    s_cbranch_scc1 qkv_hloop
    s_barrier
    s_mov_b32 s58, 0
    s_cmp_eq_u32 s33, 3
    s_cbranch_scc1 qkv_h3
qkv_gat:
    s_mov_b32 s40, s56
    buffer_load_dwordx2 v[48:49], v15, s[20:23], s40 offen offset:0 sc1
    buffer_load_dwordx2 v[50:51], v15, s[20:23], s40 offen offset:1536 sc1
    s_add_u32 s40, s40, 3072
    buffer_load_dwordx2 v[52:53], v15, s[20:23], s40 offen offset:0 sc1
    buffer_load_dwordx2 v[54:55], v15, s[20:23], s40 offen offset:1536 sc1
    s_add_u32 s40, s40, 3072
    buffer_load_dwordx2 v[56:57], v15, s[20:23], s40 offen offset:0 sc1
    buffer_load_dwordx2 v[58:59], v15, s[20:23], s40 offen offset:1536 sc1
    s_add_u32 s40, s40, 3072
    buffer_load_dwordx2 v[60:61], v15, s[20:23], s40 offen offset:0 sc1
    buffer_load_dwordx2 v[62:63], v15, s[20:23], s40 offen offset:1536 sc1
    s_add_u32 s40, s40, 3072
    s_cmp_lg_u32 s58, 0
    s_cbranch_scc1 qkv_gat1
    s_waitcnt vmcnt(8)
    s_barrier
qkv_gat1:
    s_add_u32 s58, s58, 1
    s_waitcnt vmcnt(0)
    v_xor_b32 v7, s39, v49
    v_xor_b32 v5, s39, v51
    v_or_b32 v7, v7, v5
    v_add_f32 v48, v48, v50
    v_xor_b32 v5, s39, v53
    v_or_b32 v7, v7, v5
    v_add_f32 v48, v48, v52
    v_xor_b32 v5, s39, v55
    v_or_b32 v7, v7, v5
    v_add_f32 v48, v48, v54
    v_xor_b32 v5, s39, v57
    v_or_b32 v7, v7, v5
    v_add_f32 v48, v48, v56
    v_xor_b32 v5, s39, v59
    v_or_b32 v7, v7, v5
    v_add_f32 v48, v48, v58
    v_xor_b32 v5, s39, v61
    v_or_b32 v7, v7, v5
    v_add_f32 v48, v48, v60
    v_xor_b32 v5, s39, v63
    v_or_b32 v7, v7, v5
    v_add_f32 v48, v48, v62
    v_cmp_ne_u32 vcc, 0, v7
    s_cmp_gt_u32 s58, 200000
    s_cbranch_scc1 qkv_gat2
    s_cbranch_vccnz qkv_gat
qkv_gat2:
    ds_write_b32 v14, v48 offset:4096
    s_waitcnt lgkmcnt(0)
    s_branch qkv_h9
qkv_h3:
    s_and_b32 s40, s35, 3
    s_lshl_b32 s41, s34, 2
    s_add_u32 s40, s40, s41
    s_lshl_b32 s40, s40, 16
    s_lshr_b32 s41, s35, 2
    v_lshlrev_b32 v7, 7, v6
    s_lshl_b32 s42, s41, 13
    s_add_u32 s44, s40, s42
    v_min_u32 v5, 2944, v7
    s_and_b32 s42, s41, 1
    s_add_u32 s42, s42, 1
    s_lshl_b32 s42, s42, 21
    s_bfe_u32 s43, s41, 0x10001
    s_lshl_b32 s43, s43, 15
    s_add_u32 s42, s42, s43
    s_lshr_b32 s43, s41, 2
    s_mul_i32 s43, s43, 3072
    s_add_u32 s42, s42, s43
    s_add_u32 s40, s40, s42
    s_waitcnt vmcnt(0)
    s_barrier
    buffer_load_dword v109, v7, s[20:23], s44 offen
    buffer_load_dword v109, v5, s[20:23], s40 offen
qkv_h9:
    s_barrier
    s_branch tail_entry
qkv_comp:
    s_getpc_b64 s[50:51]
pc_qkv:
    s_sub_u32 s50, s50, pc_qkv-sequential_preLN__mha_block__glu_gated_glu__prompt_kernel
    s_subb_u32 s51, s51, 0
    v_lshlrev_b32 v7, 7, v6
    global_load_dword v30, v7, s[50:51]
    v_add_u32 v7, 8192, v7
    v_min_u32 v7, code_end-sequential_preLN__mha_block__glu_gated_glu__prompt_kernel-4, v7
    global_load_dword v30, v7, s[50:51]
    v_add_u32 v7, 8192, v7
    v_min_u32 v7, code_end-sequential_preLN__mha_block__glu_gated_glu__prompt_kernel-4, v7
    global_load_dword v30, v7, s[50:51]
    s_and_b32 s44, s33, 1
    s_lshr_b32 s45, s33, 1
    v_and_b32 v7, 31, v6
    v_lshlrev_b32 v8, 7, v7
    v_bfe_u32 v7, v6, 1, 3
    v_lshrrev_b32 v5, 5, v6
    v_xor_b32 v7, v7, v5
    v_lshl_add_u32 v8, v7, 4, v8
    s_lshl_b32 s40, s44, 12
    v_add_u32 v8, s40, v8
    s_lshl_b32 s40, s45, 5
    v_xor_b32 v8, s40, v8
    v_xor_b32 v9, 32, v8
    v_xor_b32 v10, 64, v8
    v_xor_b32 v11, 96, v8
    v_bfe_u32 v7, v6, 2, 2
    v_lshrrev_b32 v5, 5, v6
    v_lshl_add_u32 v5, v5, 3, v7
    v_lshlrev_b32 v14, 7, v5
    v_lshrrev_b32 v7, 1, v7
    v_lshl_add_u32 v14, v7, 6, v14
    v_bfe_u32 v7, v6, 4, 1
    v_and_b32 v5, 3, v6
    v_lshl_add_u32 v7, v7, 2, v5
    v_lshl_add_u32 v14, v7, 3, v14
    s_lshl_b32 s40, s45, 6
    v_xor_b32 v14, s40, v14
    v_add_u32 v14, 65536, v14
    s_lshl_b32 s40, s45, 11
    v_subrev_u32 v15, s40, v14
    v_add_u32 v14, s40, v14
    v_mov_b32 v12, v14
    v_mov_b32 v13, v15
    v_lshrrev_b32 v7, 2, v6
    v_xor_b32 v7, v7, v6
    v_bfe_u32 v7, v7, 2, 1
    v_add_u32 v7, -1, v7
    v_and_b32 v16, 0x3f803f80, v7
    v_and_b32 v17, 0x3f803f80, v7
    v_and_b32 v18, 0x3f803f80, v7
    v_and_b32 v19, 0x3f803f80, v7
    v_mov_b32 v20, 0
    v_mov_b32 v21, 0
    v_mov_b32 v22, 0
    v_mov_b32 v23, 0
    v_mov_b32 v40, 0
    v_mov_b32 v41, 0
    v_mov_b32 v42, 0
    v_mov_b32 v43, 0
    v_mov_b32 v44, 0
    v_mov_b32 v45, 0
    v_mov_b32 v46, 0
    v_mov_b32 v47, 0
    v_mov_b32 v48, 0
    v_mov_b32 v49, 0
    v_mov_b32 v50, 0
    v_mov_b32 v51, 0
    v_mov_b32 v52, 0
    v_mov_b32 v53, 0
    v_mov_b32 v54, 0
    v_mov_b32 v55, 0
    v_mov_b32 v56, 0
    v_mov_b32 v57, 0
    v_mov_b32 v58, 0
    v_mov_b32 v59, 0
    v_mov_b32 v60, 0
    v_mov_b32 v61, 0
    v_mov_b32 v62, 0
    v_mov_b32 v63, 0
    v_mov_b32 v64, 0
    v_mov_b32 v65, 0
    v_mov_b32 v66, 0
    v_mov_b32 v67, 0
    v_mov_b32 v68, 0
    v_mov_b32 v69, 0
    v_mov_b32 v70, 0
    v_mov_b32 v71, 0
    v_mov_b32 v72, 0
    v_mov_b32 v73, 0
    v_mov_b32 v74, 0
    v_mov_b32 v75, 0
    v_mov_b32 v76, 0
    v_mov_b32 v77, 0
    v_mov_b32 v78, 0
    v_mov_b32 v79, 0
    v_mov_b32 v80, 0
    v_mov_b32 v81, 0
    v_mov_b32 v82, 0
    v_mov_b32 v83, 0
    v_mov_b32 v84, 0
    v_mov_b32 v85, 0
    v_mov_b32 v86, 0
    v_mov_b32 v87, 0
    v_mov_b32 v88, 0
    v_mov_b32 v89, 0
    v_mov_b32 v90, 0
    v_mov_b32 v91, 0
    v_mov_b32 v92, 0
    v_mov_b32 v93, 0
    v_mov_b32 v94, 0
    v_mov_b32 v95, 0
    v_mov_b32 v96, 0
    v_mov_b32 v97, 0
    v_mov_b32 v98, 0
    v_mov_b32 v99, 0
    v_mov_b32 v100, 0
    v_mov_b32 v101, 0
    v_mov_b32 v102, 0
    v_mov_b32 v103, 0
    v_and_b32 v7, 31, v6
    v_lshrrev_b32 v5, 5, v6
    v_mul_u32_u24 v3, 144, v7
    s_mul_i32 s40, s44, 4608
    s_add_u32 s40, s40, 8192
    v_lshl_add_u32 v4, v7, 2, v3
    v_add_u32 v4, s40, v4
    s_mul_i32 s40, s33, 4608
    s_add_u32 s40, s40, 8192
    v_lshl_add_u32 v3, v5, 4, v3
    v_add_u32 v3, s40, v3
    v_lshlrev_b32 v2, 4, v5
    s_lshl_b32 s40, s45, 7
    v_add_u32 v2, s40, v2
    v_lshlrev_b32 v28, 2, v6
    s_lshl_b32 s40, s44, 8
    v_add_u32 v28, s40, v28
    s_lshl_b32 s50, s34, 2
    s_lshl_b32 s40, s45, 1
    s_add_u32 s50, s50, s40
    s_lshl_b32 s50, s50, 16
    s_lshl_b32 s40, s35, 1
    s_add_u32 s40, s40, s44
    s_lshl_b32 s40, s40, 10
    s_add_u32 s50, s50, s40
    s_mov_b32 s52, 0x3b000000
    s_mov_b32 s53, 0x3727c5ac
    s_mov_b32 s54, 0x3eb8aa3b
    s_mov_b32 s48, 0
    s_mov_b32 s49, 0
    s_waitcnt lgkmcnt(0)
    s_add_u32 s46, s20, 11075584
    s_addc_u32 s47, s21, 0
    s_load_dword s39, s[46:47], 0
    s_lshl_b32 s37, s34, 11
    s_add_u32 s37, s37, 11010048
    s_getreg_b32 s38, hwreg(HW_REG_XCC_ID, 0, 4)
    s_waitcnt lgkmcnt(0)
    s_mul_i32 s39, s39, 0x9e3779b1
    s_add_u32 s39, s39, 0x7f4a7c15
    s_xor_b32 s38, s38, s39
    s_cmp_lg_u32 s32, 0
    s_cbranch_scc1 qkv_noid
    s_lshl_b32 s40, s35, 2
    s_add_u32 s40, s40, s37
    v_mov_b32 v7, 0
    v_mov_b32 v5, s38
    s_mov_b64 exec, 1
    buffer_store_dword v5, v7, s[20:23], s40 offen sc0 sc1
    s_mov_b64 exec, -1
qkv_noid:
    v_and_b32 v7, 31, v6
    v_lshlrev_b32 v31, 2, v7
    s_barrier
    ds_read_b128 v[104:107], v8
    ds_read_b64_tr_b16 v[108:109], v12 offset:0
    ds_read_b64_tr_b16 v[110:111], v12 offset:512
    ds_read_b64_tr_b16 v[112:113], v12 offset:8192
    ds_read_b64_tr_b16 v[114:115], v12 offset:8704
    ds_read_b64_tr_b16 v[116:117], v12 offset:16384
    ds_read_b64_tr_b16 v[118:119], v12 offset:16896
    ds_read_b128 v[120:123], v9
    ds_read_b64_tr_b16 v[124:125], v13 offset:2048
    ds_read_b64_tr_b16 v[126:127], v13 offset:2560
    ds_read_b64_tr_b16 v[128:129], v13 offset:10240
    ds_read_b64_tr_b16 v[130:131], v13 offset:10752
    ds_read_b64_tr_b16 v[132:133], v13 offset:18432
    ds_read_b64_tr_b16 v[134:135], v13 offset:18944
    buffer_load_dword v29, v31, s[20:23], s37 offen sc0 sc1
.p2align 6
qkv_loop:
    s_waitcnt lgkmcnt(7)
    v_mfma_f32_32x32x16_bf16 v[88:103], v[104:107], v[104:107], v[88:103]
    s_add_u32 s48, s48, 24576
    s_cmp_eq_u32 s48, 98304
    s_cselect_b32 s48, 0, s48
    s_add_u32 s49, s49, 1
    v_mfma_f32_32x32x16_bf16 v[40:55], v[108:111], v[104:107], v[40:55]
    ds_read_b128 v[136:139], v10
    ds_read_b64_tr_b16 v[140:141], v12 offset:4096
    ds_read_b64_tr_b16 v[142:143], v12 offset:4608
    v_mfma_f32_32x32x16_bf16 v[56:71], v[112:115], v[104:107], v[56:71]
    ds_read_b64_tr_b16 v[144:145], v12 offset:12288
    ds_read_b64_tr_b16 v[146:147], v12 offset:12800
    ds_read_b64_tr_b16 v[148:149], v12 offset:20480
    v_mfma_f32_32x32x16_bf16 v[72:87], v[116:119], v[104:107], v[72:87]
    ds_read_b64_tr_b16 v[150:151], v12 offset:20992
    ds_read_b128 v[152:155], v11
    v_mfma_f32_16x16x32_bf16 v[20:23], v[16:19], v[104:107], v[20:23]
    ds_read_b64_tr_b16 v[156:157], v13 offset:6144
    s_waitcnt lgkmcnt(9)
    v_mfma_f32_32x32x16_bf16 v[40:55], v[124:127], v[120:123], v[40:55]
    ds_read_b64_tr_b16 v[158:159], v13 offset:6656
    ds_read_b64_tr_b16 v[160:161], v13 offset:14336
    ds_read_b64_tr_b16 v[162:163], v13 offset:14848
    v_mfma_f32_32x32x16_bf16 v[56:71], v[128:131], v[120:123], v[56:71]
    ds_read_b64_tr_b16 v[164:165], v13 offset:22528
    ds_read_b64_tr_b16 v[166:167], v13 offset:23040
    v_mfma_f32_32x32x16_bf16 v[72:87], v[132:135], v[120:123], v[72:87]
    v_add_u32 v8, 8192, v8
    v_add_u32 v9, 8192, v9
    v_add_u32 v10, 8192, v10
    v_add_u32 v11, 8192, v11
    v_add_u32 v12, s48, v14
    v_add_u32 v13, s48, v15
    s_cmp_eq_u32 s49, 8
    s_cbranch_scc1 qkv_epi
    s_waitcnt lgkmcnt(7)
    v_mfma_f32_32x32x16_bf16 v[88:103], v[136:139], v[136:139], v[88:103]
    s_barrier
    v_mfma_f32_32x32x16_bf16 v[40:55], v[140:143], v[136:139], v[40:55]
    ds_read_b128 v[104:107], v8
    ds_read_b64_tr_b16 v[108:109], v12 offset:0
    ds_read_b64_tr_b16 v[110:111], v12 offset:512
    v_mfma_f32_32x32x16_bf16 v[56:71], v[144:147], v[136:139], v[56:71]
    ds_read_b64_tr_b16 v[112:113], v12 offset:8192
    ds_read_b64_tr_b16 v[114:115], v12 offset:8704
    ds_read_b64_tr_b16 v[116:117], v12 offset:16384
    v_mfma_f32_32x32x16_bf16 v[72:87], v[148:151], v[136:139], v[72:87]
    ds_read_b64_tr_b16 v[118:119], v12 offset:16896
    ds_read_b128 v[120:123], v9
    v_mfma_f32_16x16x32_bf16 v[20:23], v[16:19], v[136:139], v[20:23]
    ds_read_b64_tr_b16 v[124:125], v13 offset:2048
    s_waitcnt lgkmcnt(9)
    v_mfma_f32_32x32x16_bf16 v[40:55], v[156:159], v[152:155], v[40:55]
    ds_read_b64_tr_b16 v[126:127], v13 offset:2560
    ds_read_b64_tr_b16 v[128:129], v13 offset:10240
    ds_read_b64_tr_b16 v[130:131], v13 offset:10752
    v_mfma_f32_32x32x16_bf16 v[56:71], v[160:163], v[152:155], v[56:71]
    ds_read_b64_tr_b16 v[132:133], v13 offset:18432
    ds_read_b64_tr_b16 v[134:135], v13 offset:18944
    v_mfma_f32_32x32x16_bf16 v[72:87], v[164:167], v[152:155], v[72:87]
    s_branch qkv_loop
qkv_epi:
    s_waitcnt lgkmcnt(7)
    v_mfma_f32_32x32x16_bf16 v[88:103], v[136:139], v[136:139], v[88:103]
    v_mfma_f32_32x32x16_bf16 v[40:55], v[140:143], v[136:139], v[40:55]
    v_mfma_f32_32x32x16_bf16 v[56:71], v[144:147], v[136:139], v[56:71]
    v_mfma_f32_32x32x16_bf16 v[72:87], v[148:151], v[136:139], v[72:87]
    v_mfma_f32_16x16x32_bf16 v[20:23], v[16:19], v[136:139], v[20:23]
    s_waitcnt lgkmcnt(0)
    v_mfma_f32_32x32x16_bf16 v[40:55], v[156:159], v[152:155], v[40:55]
    s_nop 5
    ds_write_b128 v3, v[88:91] offset:0
    ds_write_b128 v3, v[92:95] offset:32
    ds_write_b128 v3, v[96:99] offset:64
    ds_write_b128 v3, v[100:103] offset:96
    v_mfma_f32_32x32x16_bf16 v[56:71], v[160:163], v[152:155], v[56:71]
    s_lshl_b32 s40, s45, 9
    v_add_u32 v7, s40, v28
    ds_write_b32 v7, v20 offset:28672
    v_mfma_f32_32x32x16_bf16 v[72:87], v[164:167], v[152:155], v[72:87]
    s_waitcnt lgkmcnt(0)
    s_barrier
    ds_read_b32 v20, v4
    ds_read_b32 v21, v4 offset:9216
    ds_read_b32 v22, v28 offset:28672
    ds_read_b32 v23, v28 offset:29184
    ds_read_b128 v[88:91], v2 offset:4096
    ds_read_b128 v[92:95], v2 offset:4128
    ds_read_b128 v[96:99], v2 offset:4160
    ds_read_b128 v[100:103], v2 offset:4192
    ds_read_b128 v[104:107], v2 offset:4352
    ds_read_b128 v[108:111], v2 offset:4384
    ds_read_b128 v[112:115], v2 offset:4416
    ds_read_b128 v[116:119], v2 offset:4448
    ds_read_b128 v[120:123], v2 offset:4608
    ds_read_b128 v[124:127], v2 offset:4640
    ds_read_b128 v[128:131], v2 offset:4672
    ds_read_b128 v[132:135], v2 offset:4704
    s_mov_b32 s40, 0
qkv_idp:
    s_waitcnt vmcnt(0)
    v_xor_b32 v30, s39, v29
    v_cmp_lt_u32 vcc, 15, v30
    s_cbranch_vccz qkv_idok
    buffer_load_dword v29, v31, s[20:23], s37 offen sc0 sc1
    s_add_u32 s40, s40, 1
    s_cmp_lt_u32 s40, 200000
    s_cbranch_scc1 qkv_idp
    s_waitcnt vmcnt(0)
qkv_idok:
    v_cmp_ne_u32 vcc, s38, v29
    s_waitcnt lgkmcnt(12)
    v_add_f32 v25, v20, v21
    v_add_f32 v24, v22, v23
    s_cmp_lg_u64 vcc, 0
    s_cselect_b32 s36, 1, 0
    v_mul_f32 v24, s52, v24
    v_mul_f32 v25, s52, v25
    v_fma_f32 v25, -v24, v24, v25
    v_max_f32 v25, 0, v25
    v_cvt_pk_bf16_f32 v16, v24, v25
    v_lshlrev_b32 v24, 16, v16
    v_and_b32 v25, 0xffff0000, v16
    v_add_f32 v25, s53, v25
    v_cvt_pk_bf16_f32 v16, v25, v25
    v_and_b32 v25, 0xffff0000, v16
    v_sqrt_f32 v25, v25
    v_sub_f32 v24, 0, v24
    v_cvt_pk_bf16_f32 v16, v25, v25
    v_and_b32 v25, 0xffff0000, v16
    v_rcp_f32 v27, v25
    s_nop 0
    v_mul_f32 v26, s54, v27
    s_waitcnt lgkmcnt(4)
    v_pk_fma_f32 v[56:57], v[104:105], v[24:25], v[56:57] op_sel_hi:[1,0,1]
    v_pk_fma_f32 v[58:59], v[106:107], v[24:25], v[58:59] op_sel_hi:[1,0,1]
    v_pk_fma_f32 v[60:61], v[108:109], v[24:25], v[60:61] op_sel_hi:[1,0,1]
    v_pk_fma_f32 v[62:63], v[110:111], v[24:25], v[62:63] op_sel_hi:[1,0,1]
    v_pk_fma_f32 v[64:65], v[112:113], v[24:25], v[64:65] op_sel_hi:[1,0,1]
    v_pk_fma_f32 v[66:67], v[114:115], v[24:25], v[66:67] op_sel_hi:[1,0,1]
    v_pk_fma_f32 v[68:69], v[116:117], v[24:25], v[68:69] op_sel_hi:[1,0,1]
    v_pk_fma_f32 v[70:71], v[118:119], v[24:25], v[70:71] op_sel_hi:[1,0,1]
    v_pk_mul_f32 v[56:57], v[56:57], v[26:27] op_sel:[0,1]
    v_pk_mul_f32 v[58:59], v[58:59], v[26:27] op_sel:[0,1]
    v_pk_mul_f32 v[60:61], v[60:61], v[26:27] op_sel:[0,1]
    v_pk_mul_f32 v[62:63], v[62:63], v[26:27] op_sel:[0,1]
    v_pk_mul_f32 v[64:65], v[64:65], v[26:27] op_sel:[0,1]
    v_pk_mul_f32 v[66:67], v[66:67], v[26:27] op_sel:[0,1]
    v_pk_mul_f32 v[68:69], v[68:69], v[26:27] op_sel:[0,1]
    v_pk_mul_f32 v[70:71], v[70:71], v[26:27] op_sel:[0,1]
    v_cvt_pk_bf16_f32 v56, v56, v57
    v_cvt_pk_bf16_f32 v57, v58, v59
    v_cvt_pk_bf16_f32 v58, v60, v61
    v_cvt_pk_bf16_f32 v59, v62, v63
    v_cvt_pk_bf16_f32 v60, v64, v65
    v_cvt_pk_bf16_f32 v61, v66, v67
    v_cvt_pk_bf16_f32 v62, v68, v69
    v_cvt_pk_bf16_f32 v63, v70, v71
    s_add_u32 s40, s50, 2097152
    s_add_u32 s41, s50, 2162688
    s_cmp_lg_u32 s36, 0
    s_cbranch_scc1 tail_sq1_d
    buffer_store_dwordx4 v[56:59], v1, s[20:23], s40 offen
    buffer_store_dwordx4 v[60:63], v1, s[20:23], s41 offen
    s_branch tail_sq1_e
tail_sq1_d:
    buffer_store_dwordx4 v[56:59], v1, s[20:23], s40 offen sc0 sc1
    buffer_store_dwordx4 v[60:63], v1, s[20:23], s41 offen sc0 sc1
tail_sq1_e:
    s_waitcnt lgkmcnt(0)
    v_pk_fma_f32 v[72:73], v[120:121], v[24:25], v[72:73] op_sel_hi:[1,0,1]
    v_pk_fma_f32 v[74:75], v[122:123], v[24:25], v[74:75] op_sel_hi:[1,0,1]
    v_pk_fma_f32 v[76:77], v[124:125], v[24:25], v[76:77] op_sel_hi:[1,0,1]
    v_pk_fma_f32 v[78:79], v[126:127], v[24:25], v[78:79] op_sel_hi:[1,0,1]
    v_pk_fma_f32 v[80:81], v[128:129], v[24:25], v[80:81] op_sel_hi:[1,0,1]
    v_pk_fma_f32 v[82:83], v[130:131], v[24:25], v[82:83] op_sel_hi:[1,0,1]
    v_pk_fma_f32 v[84:85], v[132:133], v[24:25], v[84:85] op_sel_hi:[1,0,1]
    v_pk_fma_f32 v[86:87], v[134:135], v[24:25], v[86:87] op_sel_hi:[1,0,1]
    v_pk_mul_f32 v[72:73], v[72:73], v[26:27] op_sel:[0,1]
    v_pk_mul_f32 v[74:75], v[74:75], v[26:27] op_sel:[0,1]
    v_pk_mul_f32 v[76:77], v[76:77], v[26:27] op_sel:[0,1]
    v_pk_mul_f32 v[78:79], v[78:79], v[26:27] op_sel:[0,1]
    v_pk_mul_f32 v[80:81], v[80:81], v[26:27] op_sel:[0,1]
    v_pk_mul_f32 v[82:83], v[82:83], v[26:27] op_sel:[0,1]
    v_pk_mul_f32 v[84:85], v[84:85], v[26:27] op_sel:[0,1]
    v_pk_mul_f32 v[86:87], v[86:87], v[26:27] op_sel:[0,1]
    v_cvt_pk_bf16_f32 v72, v72, v73
    v_cvt_pk_bf16_f32 v73, v74, v75
    v_cvt_pk_bf16_f32 v74, v76, v77
    v_cvt_pk_bf16_f32 v75, v78, v79
    v_cvt_pk_bf16_f32 v76, v80, v81
    v_cvt_pk_bf16_f32 v77, v82, v83
    v_cvt_pk_bf16_f32 v78, v84, v85
    v_cvt_pk_bf16_f32 v79, v86, v87
    s_add_u32 s40, s50, 4194304
    s_add_u32 s41, s50, 4259840
    s_cmp_lg_u32 s36, 0
    s_cbranch_scc1 tail_sq2_d
    buffer_store_dwordx4 v[72:75], v1, s[20:23], s40 offen
    buffer_store_dwordx4 v[76:79], v1, s[20:23], s41 offen
    s_branch tail_sq2_e
tail_sq2_d:
    buffer_store_dwordx4 v[72:75], v1, s[20:23], s40 offen sc0 sc1
    buffer_store_dwordx4 v[76:79], v1, s[20:23], s41 offen sc0 sc1
tail_sq2_e:
    s_waitcnt lgkmcnt(0)
    v_pk_fma_f32 v[40:41], v[88:89], v[24:25], v[40:41] op_sel_hi:[1,0,1]
    v_pk_fma_f32 v[42:43], v[90:91], v[24:25], v[42:43] op_sel_hi:[1,0,1]
    v_pk_fma_f32 v[44:45], v[92:93], v[24:25], v[44:45] op_sel_hi:[1,0,1]
    v_pk_fma_f32 v[46:47], v[94:95], v[24:25], v[46:47] op_sel_hi:[1,0,1]
    v_pk_fma_f32 v[48:49], v[96:97], v[24:25], v[48:49] op_sel_hi:[1,0,1]
    v_pk_fma_f32 v[50:51], v[98:99], v[24:25], v[50:51] op_sel_hi:[1,0,1]
    v_pk_fma_f32 v[52:53], v[100:101], v[24:25], v[52:53] op_sel_hi:[1,0,1]
    v_pk_fma_f32 v[54:55], v[102:103], v[24:25], v[54:55] op_sel_hi:[1,0,1]
    v_pk_mul_f32 v[40:41], v[40:41], v[26:27] op_sel_hi:[1,0]
    v_pk_mul_f32 v[42:43], v[42:43], v[26:27] op_sel_hi:[1,0]
    v_pk_mul_f32 v[44:45], v[44:45], v[26:27] op_sel_hi:[1,0]
    v_pk_mul_f32 v[46:47], v[46:47], v[26:27] op_sel_hi:[1,0]
    v_pk_mul_f32 v[48:49], v[48:49], v[26:27] op_sel_hi:[1,0]
    v_pk_mul_f32 v[50:51], v[50:51], v[26:27] op_sel_hi:[1,0]
    v_pk_mul_f32 v[52:53], v[52:53], v[26:27] op_sel_hi:[1,0]
    v_pk_mul_f32 v[54:55], v[54:55], v[26:27] op_sel_hi:[1,0]
    v_cvt_pk_bf16_f32 v40, v40, v41
    v_cvt_pk_bf16_f32 v41, v42, v43
    v_cvt_pk_bf16_f32 v42, v44, v45
    v_cvt_pk_bf16_f32 v43, v46, v47
    v_cvt_pk_bf16_f32 v44, v48, v49
    v_cvt_pk_bf16_f32 v45, v50, v51
    v_cvt_pk_bf16_f32 v46, v52, v53
    v_cvt_pk_bf16_f32 v47, v54, v55
    s_add_u32 s40, s50, 0
    s_add_u32 s41, s50, 65536
    s_cmp_lg_u32 s36, 0
    s_cbranch_scc1 tail_sq0_d
    buffer_store_dwordx4 v[40:43], v1, s[20:23], s40 offen
    buffer_store_dwordx4 v[44:47], v1, s[20:23], s41 offen
    s_branch tail_sq0_e
tail_sq0_d:
    buffer_store_dwordx4 v[40:43], v1, s[20:23], s40 offen sc0 sc1
    buffer_store_dwordx4 v[44:47], v1, s[20:23], s41 offen sc0 sc1
tail_sq0_e:
    s_lshl_b32 s40, s35, 2
    s_add_u32 s40, s40, s33
    s_lshl_b32 s40, s40, 2
    s_add_u32 s40, s40, s37
    v_mov_b32 v7, 0
    v_mov_b32 v5, s39
    s_mov_b64 exec, 1
    s_waitcnt vmcnt(0)
    s_cmp_lg_u32 s36, 0
    s_cbranch_scc1 tail_f0_d
    buffer_store_dword v5, v7, s[20:23], s40 offen offset:512
    s_branch tail_f0_e
tail_f0_d:
    buffer_store_dword v5, v7, s[20:23], s40 offen offset:512 sc0 sc1
tail_f0_e:
    s_mov_b64 exec, -1
tail_entry:
    s_and_b32 s41, s35, 3
    s_lshl_b32 s40, s34, 2
    s_add_u32 s3, s41, s40
    s_lshl_b32 s41, s3, 16
    s_lshr_b32 s42, s32, 2
    s_lshl_b32 s43, s42, 15
    s_and_b32 s44, s32, 1
    s_bfe_u32 s45, s32, 0x10001
    s_lshl_b32 s45, s45, 10
    s_add_u32 s45, s45, s43
    s_bfe_u32 s46, s32, 0x10001
    s_lshl_b32 s46, s46, 12
    s_lshl_b32 s40, s44, 11
    s_add_u32 s46, s46, s40
    s_lshl_b32 s57, s42, 10
    s_add_u32 s46, s46, s57
    s_lshl_b32 s47, s44, 21
    s_add_u32 s47, s47, s45
    s_add_u32 s47, s47, s41
    s_add_u32 s47, s47, 2097152
    s_and_b32 s48, s35, 28
    s_add_u32 s48, s48, s33
    s_lshl_b32 s48, s48, 11
    s_add_u32 s48, s48, s41
    v_lshrrev_b32 v5, 5, v6
    v_mul_u32_u24 v7, s44, v5
    v_lshlrev_b32 v7, 6, v7
    v_xor_b32 v108, v7, v1
    s_mov_b32 m0, s46
    v_and_b32 v7, 2, v0
    v_add_u32 v7, -1, v7
    v_ashrrev_i32 v7, 31, v7
    v_and_b32 v36, 0x3f80, v7
    v_mov_b32 v37, 0
    v_lshlrev_b32 v7, 3, v0
    v_add_u32 v7, 131072, v7
    v_mov_b32 v114, v7
    v_add_u32 v2, s57, v1
    v_and_b32 v7, 1, v6
    v_lshlrev_b32 v110, 9, v7
    v_xor_b32 v7, v7, v5
    v_lshl_add_u32 v110, v7, 6, v110
    v_bfe_u32 v7, v6, 2, 2
    v_lshl_add_u32 v110, v7, 4, v110
    v_bfe_u32 v7, v6, 1, 1
    v_lshl_add_u32 v110, v7, 3, v110
    s_add_u32 s40, s57, 2048
    v_add_u32 v3, s40, v110
    v_and_b32 v7, 15, v6
    v_lshlrev_b32 v7, 3, v7
    v_add_u32 v7, 131200, v7
    v_and_b32 v5, 16, v6
    v_cmp_eq_u32 s[50:51], 0, v5
    v_mov_b32 v4, 8192
    v_mov_b32 v40, 0
    v_mov_b32 v41, 0
    v_mov_b32 v42, 0
    v_mov_b32 v43, 0
    v_cndmask_b32 v3, v7, v3, s[50:51]
    v_cndmask_b32 v4, 0, v4, s[50:51]
    v_mov_b32 v32, 0
    v_mov_b32 v33, 0
    v_mov_b32 v34, 0
    v_mov_b32 v35, 0
    v_mov_b32 v76, 0
    v_mov_b32 v77, 0
    v_mov_b32 v78, 0
    v_mov_b32 v79, 0
    v_mov_b32 v80, 0
    v_mov_b32 v81, 0
    v_mov_b32 v82, 0
    v_mov_b32 v83, 0
    v_mov_b32 v84, 0
    v_mov_b32 v85, 0
    v_mov_b32 v86, 0
    v_mov_b32 v87, 0
    v_mov_b32 v88, 0
    v_mov_b32 v89, 0
    v_mov_b32 v90, 0
    v_mov_b32 v91, 0
    v_mov_b32 v92, 0
    v_mov_b32 v93, 0
    v_mov_b32 v94, 0
    v_mov_b32 v95, 0
    v_mov_b32 v96, 0
    v_mov_b32 v97, 0
    v_mov_b32 v98, 0
    v_mov_b32 v99, 0
    v_mov_b32 v100, 0
    v_mov_b32 v101, 0
    v_mov_b32 v102, 0
    v_mov_b32 v103, 0
    v_mov_b32 v104, 0
    v_mov_b32 v105, 0
    v_mov_b32 v106, 0
    v_mov_b32 v107, 0
    v_lshlrev_b32 v111, 7, v6
    s_lshl_b32 s52, s32, 5
    s_add_u32 s52, s52, s35
    s_lshl_b32 s52, s52, 13
    s_lshr_b32 s40, s52, 13
    s_mul_i32 s55, s34, 720896
    s_add_u32 s55, s55, 11534336
    s_add_u32 s55, s55, s52
    s_cmp_lt_u32 s40, 88
    s_cbranch_scc1 tail_tch
    s_lshl_b32 s55, s34, 18
    s_add_u32 s55, s55, s52
    s_add_u32 s55, s55, 7667712
    s_cmp_lt_u32 s40, 120
    s_cbranch_scc1 tail_tch
    s_lshl_b32 s55, s34, 15
    s_add_u32 s55, s55, s52
    s_add_u32 s55, s55, 9502720
    s_cmp_lt_u32 s40, 124
    s_cselect_b32 s55, s55, 0x40000000
tail_tch:
    v_and_b32 v7, 31, v6
    v_lshlrev_b32 v113, 10, v7
    v_lshrrev_b32 v7, 5, v6
    v_lshl_add_u32 v113, v7, 3, v113
    s_and_b32 s56, s35, 3
    s_lshl_b32 s40, s34, 2
    s_add_u32 s56, s56, s40
    s_lshl_b32 s56, s56, 1
    s_and_b32 s40, s32, 1
    s_add_u32 s56, s56, s40
    s_lshl_b32 s56, s56, 15
    s_lshr_b32 s40, s35, 2
    s_lshl_b32 s40, s40, 7
    s_add_u32 s56, s56, s40
    s_bfe_u32 s40, s32, 0x10001
    s_lshl_b32 s40, s40, 6
    s_add_u32 s56, s56, s40
    s_cmp_lt_u32 s32, 4
    s_cselect_b32 s56, s56, 0x40000000
    v_lshrrev_b32 v7, 3, v6
    v_lshlrev_b32 v112, 10, v7
    v_lshrrev_b32 v7, 2, v6
    v_and_b32 v7, 4, v7
    v_and_b32 v5, 7, v6
    v_xor_b32 v7, v7, v5
    v_lshl_add_u32 v112, v7, 4, v112
    s_lshr_b32 s53, s35, 2
    s_lshl_b32 s53, s53, 7
    s_lshl_b32 s40, s33, 14
    s_add_u32 s53, s53, s40
    s_lshl_b32 s54, s33, 11
    v_add_u32 v116, 7168, v112
    v_lshrrev_b32 v7, 2, v6
    v_mul_u32_u24 v115, 2752, v7
    v_and_b32 v7, 3, v6
    v_lshl_add_u32 v115, v7, 4, v115
    s_lshr_b32 s58, s35, 1
    s_mul_i32 s58, s58, 192
    s_mul_i32 s40, s33, 44032
    s_add_u32 s58, s58, s40
    s_mul_i32 s40, s34, 176128
    s_add_u32 s58, s58, s40
    s_lshl_b32 s59, s33, 10
    s_add_u32 s59, s59, 73728
    s_mov_b64 s[24:25], s[8:9]
    s_mov_b32 s26, 524288
    s_mov_b32 s27, 0x20000
    s_mov_b32 s31, 0x20000
    s_cmp_lg_u32 s32, 7
    s_cbranch_scc1 tail_q_h
    v_lshlrev_b32 v7, 3, v6
    s_mov_b32 s40, 0
tail_p0:
    buffer_load_dwordx2 v[44:45], v7, s[20:23], s37 offen offset:512 sc1
    s_add_u32 s40, s40, 1
    s_cmp_gt_u32 s40, 200000
    s_cbranch_scc1 tail_p0_x
    s_waitcnt vmcnt(0)
    v_xor_b32 v44, s39, v44
    v_xor_b32 v45, s39, v45
    v_or_b32 v44, v44, v45
    v_cmp_ne_u32 vcc, 0, v44
    s_cbranch_vccnz tail_p0
tail_p0_x:
tail_q_h:
    s_barrier
    buffer_load_dwordx4 v108, s[20:23], s47 offen sc1 lds
    s_add_u32 m0, m0, 8192
    s_add_u32 s47, s47, 2048
    buffer_load_dwordx4 v[8:11], v1, s[20:23], s48 offen sc1
    buffer_load_dwordx4 v[12:15], v1, s[20:23], s48 offen offset:1024 sc1
    buffer_load_dwordx4 v108, s[20:23], s47 offen sc1 lds
    s_add_u32 m0, m0, 8192
    s_add_u32 s47, s47, 2048
    buffer_load_dwordx4 v108, s[20:23], s47 offen sc1 lds
    s_add_u32 m0, m0, 8192
    s_add_u32 s47, s47, 2048
    ds_write_b64 v114, v[36:37]
    ds_write_b64 v114, v[36:37] offset:4096
    ds_write_b64 v114, v[36:37] offset:6144
    s_waitcnt vmcnt(0) lgkmcnt(0)
    s_barrier
    ds_read_b128 v[16:19], v2 offset:0
    ds_read_b64_tr_b16 v[20:21], v3 offset:0
    ds_read_b64_tr_b16 v[22:23], v3 offset:128
    ds_read_b64_tr_b16 v[24:25], v3 offset:256
    ds_read_b64_tr_b16 v[26:27], v3 offset:384
    buffer_load_dwordx4 v108, s[20:23], s47 offen sc1 lds
    s_add_u32 m0, m0, 8192
    s_add_u32 s47, s47, 2048
    buffer_load_dwordx4 v108, s[20:23], s47 offen sc1 lds
    s_add_u32 m0, m0, 8192
    s_add_u32 s47, s47, 2048
    buffer_load_dwordx4 v108, s[20:23], s47 offen sc1 lds
    s_add_u32 m0, m0, 8192
    s_add_u32 s47, s47, 2048
    buffer_load_dwordx4 v108, s[20:23], s47 offen sc1 lds
    s_add_u32 m0, m0, 8192
    s_add_u32 s47, s47, 2048
    s_waitcnt lgkmcnt(4)
    v_mfma_f32_32x32x16_bf16 v[44:59], v[16:19], v[8:11], 0
    s_nop 7
    s_nop 1
    s_setprio 3
    s_call_b64 s[66:67], tail_aloop
    s_cmp_ge_u32 s32, 4
    s_cbranch_scc1 tail_it1y
    s_add_u32 s40, s47, 31744
    buffer_load_dwordx4 v108, s[20:23], s47 offen sc1 lds
    buffer_load_dwordx4 v108, s[20:23], s40 offen offset:1024 sc1 lds
    s_add_u32 m0, m0, 8192
    s_add_u32 s47, s47, 2048
    s_add_u32 s40, s47, 31744
    buffer_load_dwordx4 v108, s[20:23], s47 offen sc1 lds
    buffer_load_dwordx4 v108, s[20:23], s40 offen offset:1024 sc1 lds
    s_add_u32 m0, m0, 8192
    s_add_u32 s47, s47, 2048
    s_add_u32 s40, s47, 31744
    buffer_load_dwordx4 v108, s[20:23], s47 offen sc1 lds
    buffer_load_dwordx4 v108, s[20:23], s40 offen offset:1024 sc1 lds
    s_add_u32 m0, m0, 8192
    s_add_u32 s47, s47, 2048
    s_add_u32 s40, s47, 31744
    buffer_load_dwordx4 v108, s[20:23], s47 offen sc1 lds
    buffer_load_dwordx4 v108, s[20:23], s40 offen offset:1024 sc1 lds
    s_add_u32 m0, m0, 8192
    s_add_u32 s47, s47, 2048
    s_waitcnt vmcnt(8)
    s_barrier
    s_add_u32 s40, s47, 31744
    buffer_load_dwordx4 v108, s[20:23], s47 offen sc1 lds
    buffer_load_dwordx4 v108, s[20:23], s40 offen offset:1024 sc1 lds
    s_add_u32 m0, m0, 8192
    s_add_u32 s47, s47, 2048
    s_add_u32 s40, s47, 31744
    buffer_load_dwordx4 v108, s[20:23], s47 offen sc1 lds
    buffer_load_dwordx4 v108, s[20:23], s40 offen offset:1024 sc1 lds
    s_add_u32 m0, m0, 8192
    s_add_u32 s47, s47, 2048
    s_add_u32 s40, s47, 31744
    buffer_load_dwordx4 v108, s[20:23], s47 offen sc1 lds
    buffer_load_dwordx4 v108, s[20:23], s40 offen offset:1024 sc1 lds
    s_add_u32 m0, m0, 8192
    s_add_u32 s47, s47, 2048
    s_add_u32 s40, s47, 31744
    buffer_load_dwordx4 v108, s[20:23], s47 offen sc1 lds
    buffer_load_dwordx4 v108, s[20:23], s40 offen offset:1024 sc1 lds
    s_add_u32 m0, m0, 8192
    s_add_u32 s47, s47, 2048
    s_add_u32 s40, s47, 31744
    buffer_load_dwordx4 v108, s[20:23], s47 offen sc1 lds
    buffer_load_dwordx4 v108, s[20:23], s40 offen offset:1024 sc1 lds
    s_add_u32 m0, m0, 8192
    s_add_u32 s47, s47, 2048
    s_mov_b64 s[28:29], s[14:15]
    s_mov_b32 s30, 1409024
    s_cmp_eq_u32 s32, 1
    s_cselect_b64 s[28:29], s[12:13], s[28:29]
    s_cselect_b32 s30, 1409024, s30
    s_cmp_eq_u32 s32, 2
    s_cselect_b64 s[28:29], s[16:17], s[28:29]
    s_cselect_b32 s30, 1409024, s30
    s_cmp_eq_u32 s32, 3
    s_cselect_b64 s[28:29], s[8:9], s[28:29]
    s_cselect_b32 s30, 524288, s30
    s_lshl_b32 s40, s2, 13
    buffer_load_dword v109, v111, s[28:31], s40 offen
    s_branch tail_it1
tail_it1y:
    s_waitcnt vmcnt(0)
    s_barrier
tail_it1:
    s_call_b64 s[66:67], tail_aloop
    s_cmp_ge_u32 s32, 4
    s_cbranch_scc1 tail_it2y
    s_barrier
    s_mov_b64 s[28:29], s[14:15]
    s_mov_b32 s30, 1409024
    buffer_load_dword v109, v111, s[28:31], s52 offen
    s_branch tail_it2
tail_it2y:
    s_barrier
tail_it2:
    s_call_b64 s[66:67], tail_aloop
    s_cmp_ge_u32 s32, 4
    s_cbranch_scc1 tail_it3y
    s_waitcnt vmcnt(2)
    s_barrier
    s_mov_b64 s[28:29], s[12:13]
    s_mov_b32 s30, 1409024
    buffer_load_dword v109, v111, s[28:31], s52 offen
    s_branch tail_it3
tail_it3y:
    s_barrier
tail_it3:
    s_call_b64 s[66:67], tail_aloop
    s_cmp_ge_u32 s32, 4
    s_cbranch_scc1 tail_it4y
    s_barrier
    s_mov_b64 s[28:29], s[14:15]
    s_mov_b32 s30, 1409024
    s_add_u32 s40, s52, 1048576
    buffer_load_dword v109, v111, s[28:31], s40 offen
    s_mov_b64 s[28:29], s[12:13]
    s_mov_b32 s30, 1409024
    s_add_u32 s40, s52, 1048576
    buffer_load_dword v109, v111, s[28:31], s40 offen
    s_branch tail_it4
tail_it4y:
    s_barrier
tail_it4:
    s_call_b64 s[66:67], tail_aloop
    s_cmp_ge_u32 s32, 4
    s_cbranch_scc1 tail_it5y
    s_barrier
    s_add_u32 m0, s54, 0
    s_add_u32 s40, s53, 0
    buffer_load_dwordx4 v112, s[24:27], s40 offen lds
    buffer_load_dwordx4 v116, s[24:27], s40 offen offset:1024 lds
    s_add_u32 m0, s54, 8192
    s_add_u32 s40, s53, 65536
    buffer_load_dwordx4 v112, s[24:27], s40 offen lds
    buffer_load_dwordx4 v116, s[24:27], s40 offen offset:1024 lds
    s_add_u32 m0, s54, 16384
    s_add_u32 s40, s53, 131072
    buffer_load_dwordx4 v112, s[24:27], s40 offen lds
    buffer_load_dwordx4 v116, s[24:27], s40 offen offset:1024 lds
    s_add_u32 m0, s54, 24576
    s_add_u32 s40, s53, 196608
    buffer_load_dwordx4 v112, s[24:27], s40 offen lds
    buffer_load_dwordx4 v116, s[24:27], s40 offen offset:1024 lds
    s_add_u32 s53, s53, 0x40000
    s_add_u32 s54, s54, 32768
    s_branch tail_it5
tail_it5y:
    s_barrier
tail_it5:
    s_call_b64 s[66:67], tail_aloop
    s_cmp_ge_u32 s32, 4
    s_cbranch_scc1 tail_it6y
    s_mov_b64 s[28:29], s[4:5]
    s_mov_b32 s30, 2097152
    buffer_load_dwordx2 v[216:217], v113, s[28:31], s56 offen offset:0
    buffer_load_dwordx2 v[218:219], v113, s[28:31], s56 offen offset:16
    buffer_load_dwordx2 v[220:221], v113, s[28:31], s56 offen offset:32
    buffer_load_dwordx2 v[222:223], v113, s[28:31], s56 offen offset:48
    s_barrier
    s_add_u32 m0, s54, 0
    s_add_u32 s40, s53, 0
    buffer_load_dwordx4 v112, s[24:27], s40 offen lds
    buffer_load_dwordx4 v116, s[24:27], s40 offen offset:1024 lds
    s_add_u32 m0, s54, 8192
    s_add_u32 s40, s53, 65536
    buffer_load_dwordx4 v112, s[24:27], s40 offen lds
    buffer_load_dwordx4 v116, s[24:27], s40 offen offset:1024 lds
    s_add_u32 m0, s54, 16384
    s_add_u32 s40, s53, 131072
    buffer_load_dwordx4 v112, s[24:27], s40 offen lds
    buffer_load_dwordx4 v116, s[24:27], s40 offen offset:1024 lds
    s_add_u32 m0, s54, 24576
    s_add_u32 s40, s53, 196608
    buffer_load_dwordx4 v112, s[24:27], s40 offen lds
    buffer_load_dwordx4 v116, s[24:27], s40 offen offset:1024 lds
    s_add_u32 s53, s53, 0x40000
    s_add_u32 s54, s54, 32768
    s_branch tail_it6
tail_it6y:
    s_barrier
tail_it6:
    s_call_b64 s[66:67], tail_aloop
    s_cmp_ge_u32 s32, 4
    s_cbranch_scc1 tail_it7y
    s_mov_b32 m0, s59
    s_mov_b64 s[28:29], s[12:13]
    s_mov_b32 s30, 1409024
    buffer_load_dwordx4 v115, s[28:31], s58 offen offset:0 lds
    s_add_u32 m0, m0, 4032
    s_nop 0
    buffer_load_dwordx4 v115, s[28:31], s58 offen offset:64 lds
    s_add_u32 m0, m0, 4032
    s_nop 0
    buffer_load_dwordx4 v115, s[28:31], s58 offen offset:128 lds
    s_add_u32 m0, m0, 4224
    s_nop 0
    s_mov_b64 s[28:29], s[14:15]
    s_mov_b32 s30, 1409024
    buffer_load_dwordx4 v115, s[28:31], s58 offen offset:0 lds
    s_add_u32 m0, m0, 4032
    s_nop 0
    buffer_load_dwordx4 v115, s[28:31], s58 offen offset:64 lds
    s_add_u32 m0, m0, 4032
    s_nop 0
    buffer_load_dwordx4 v115, s[28:31], s58 offen offset:128 lds
    s_add_u32 m0, m0, 4224
    s_nop 0
    s_barrier
    buffer_load_dword v109, v111, s[20:23], s55 offen
    s_sub_u32 s40, s52, 1015808
    s_cmp_ge_u32 s40, 16384
    s_cbranch_scc1 tail_nocode
    s_getpc_b64 s[60:61]
tail_pc:
    v_add_u32 v7, s40, v111
    v_min_u32 v7, code_end-tail_pc-4, v7
    global_load_dword v109, v7, s[60:61]
tail_nocode:
    s_branch tail_it7
tail_it7y:
    s_barrier
tail_it7:
    s_call_b64 s[66:67], tail_aloop
    s_setprio 0
tail_adone:
    s_nop 1
    v_mfma_f32_32x32x16_bf16 v[92:107], v[32:35], v[40:43], v[92:107]
    s_nop 2
    s_lshl_b32 s40, s33, 1
    s_add_u32 s40, s40, s42
    s_mul_i32 s43, s40, 2304
    s_xor_b32 s40, s40, 1
    s_mul_i32 s40, s40, 2304
    s_add_u32 s40, s40, 141312
    s_add_u32 s43, s43, 141312
    v_lshlrev_b32 v5, 2, v6
    v_add_u32 v2, s40, v1
    v_add_u32 v3, s40, v5
    v_add_u32 v7, s43, v1
    v_add_u32 v5, s43, v5
    s_cmp_eq_u32 s42, 0
    s_cbranch_scc1 tail_k0
    ds_write_b128 v2, v[76:79]
    ds_write_b128 v2, v[80:83] offset:1024
    ds_write_b32 v3, v84 offset:2048
    s_add_u32 s48, s48, 1024
    v_mov_b32 v8, v12
    v_mov_b32 v9, v13
    v_mov_b32 v10, v14
    v_mov_b32 v11, v15
    s_waitcnt lgkmcnt(0)
    v_mov_b32 v76, v92
    v_mov_b32 v77, v93
    v_mov_b32 v78, v94
    v_mov_b32 v79, v95
    v_mov_b32 v80, v96
    v_mov_b32 v81, v97
    v_mov_b32 v82, v98
    v_mov_b32 v83, v99
    v_mov_b32 v84, v100
    s_branch tail_bar
tail_k0:
    ds_write_b128 v2, v[92:95]
    ds_write_b128 v2, v[96:99] offset:1024
    ds_write_b32 v3, v100 offset:2048
    s_waitcnt lgkmcnt(0)
tail_bar:
    s_barrier
    ds_read_b128 v[44:47], v7
    ds_read_b128 v[48:51], v7 offset:1024
    ds_read_b32 v52, v5 offset:2048
    s_mov_b32 s44, 0xd800000
    s_mov_b32 s45, 0x76800000
    s_mov_b32 s46, 0x7e800000
    s_waitcnt lgkmcnt(0)
    v_pk_add_f32 v[76:77], v[76:77], v[44:45]
    v_pk_add_f32 v[78:79], v[78:79], v[46:47]
    v_pk_add_f32 v[80:81], v[80:81], v[48:49]
    v_pk_add_f32 v[82:83], v[82:83], v[50:51]
    v_add_f32 v84, v84, v52
    v_max3_f32 v7, |v76|, |v77|, |v78|
    v_max3_f32 v7, |v79|, |v80|, v7
    v_max3_f32 v7, |v81|, |v82|, v7
    v_max_f32 v7, |v83|, v7
    v_cmp_nge_f32 s[56:57], v84, s44
    v_cmp_nle_f32 s[58:59], v84, s45
    v_cmp_nle_f32 vcc, v7, s46
    s_or_b64 s[56:57], s[56:57], s[58:59]
    s_or_b64 s[56:57], s[56:57], vcc
    s_cmp_eq_u64 s[56:57], 0
    s_cbranch_scc0 tail_slow
tail_fin:
    v_rcp_f32 v7, v84
    s_add_u32 s48, s48, 6291456
    v_mul_f32 v76, v76, v7
    v_mul_f32 v77, v77, v7
    v_mul_f32 v78, v78, v7
    v_mul_f32 v79, v79, v7
    v_mul_f32 v80, v80, v7
    v_mul_f32 v81, v81, v7
    v_mul_f32 v82, v82, v7
    v_mul_f32 v83, v83, v7
    v_cvt_pk_bf16_f32 v36, v76, v77
    v_cvt_pk_bf16_f32 v37, v78, v79
    v_cvt_pk_bf16_f32 v38, v80, v81
    v_cvt_pk_bf16_f32 v39, v82, v83
    buffer_store_dwordx4 v[36:39], v1, s[20:23], s48 offen sc0 sc1
    s_bfe_u32 s40, s48, 0x6000a
    s_lshl_b32 s40, s40, 5
    s_add_u32 s40, s40, s3
    s_lshl_b32 s40, s40, 2
    s_add_u32 s40, s40, 11026432
    v_mov_b32 v7, 0
    v_mov_b32 v5, s39
    s_mov_b64 exec, 1
    s_waitcnt vmcnt(0)
    buffer_store_dword v5, v7, s[20:23], s40 offen sc0 sc1
    s_mov_b64 exec, -1
    s_barrier
    s_cmp_lt_u32 s32, 4
    s_cbranch_scc1 tail_comp
    s_lshr_b32 s42, s35, 2
    s_lshr_b32 s43, s35, 1
    s_mul_i32 s47, s43, 192
    s_mul_i32 s40, s33, 44032
    s_add_u32 s47, s47, s40
    s_add_u32 s46, s47, 1409024
    s_add_u32 s40, s34, 1
    s_and_b32 s40, s40, 7
    s_mul_i32 s40, s40, 176128
    s_add_u32 s47, s47, s40
    s_lshl_b32 s48, s33, 10
    s_lshl_b32 s45, s33, 11
    s_mov_b64 s[24:25], s[12:13]
    s_mov_b32 s26, 1409024
    s_mov_b64 s[28:29], s[14:15]
    s_mov_b32 s30, 1409024
    v_add_u32 v8, 7168, v112
    s_lshl_b32 s52, s42, 7
    s_lshl_b32 s40, s33, 14
    s_add_u32 s52, s52, s40
    s_mov_b64 s[56:57], s[16:17]
    s_mov_b32 s58, 1409024
    s_mov_b32 s59, 0x20000
    s_cmp_ge_u32 s43, 15
    s_cbranch_scc1 tail_hidle
    s_add_u32 m0, s48, 98304
    s_call_b64 s[64:65], tail_w4
    s_add_u32 m0, s48, 122880
    s_call_b64 s[64:65], tail_w4
    v_bfe_u32 v7, v6, 2, 2
    v_lshrrev_b32 v5, 5, v6
    v_lshl_add_u32 v7, v5, 2, v7
    v_lshlrev_b32 v9, 6, v7
    v_bfe_u32 v7, v6, 4, 1
    v_lshl_add_u32 v9, v7, 5, v9
    v_and_b32 v7, 3, v6
    v_lshl_add_u32 v9, v7, 3, v9
    v_add_u32 v9, s48, v9
    v_lshrrev_b32 v7, 2, v6
    v_xor_b32 v7, v7, v6
    v_bfe_u32 v7, v7, 2, 1
    v_add_u32 v7, -1, v7
    v_and_b32 v12, 0x3f803f80, v7
    v_and_b32 v13, 0x3f803f80, v7
    v_and_b32 v14, 0x3f803f80, v7
    v_and_b32 v15, 0x3f803f80, v7
    v_mov_b32 v16, 0
    v_mov_b32 v17, 0
    v_mov_b32 v18, 0
    v_mov_b32 v19, 0
    v_mov_b32 v20, 0
    v_mov_b32 v21, 0
    v_mov_b32 v22, 0
    v_mov_b32 v23, 0
    v_mov_b32 v24, 0
    v_mov_b32 v25, 0
    v_mov_b32 v26, 0
    v_mov_b32 v27, 0
    v_mov_b32 v28, 0
    v_mov_b32 v29, 0
    v_mov_b32 v30, 0
    v_mov_b32 v31, 0
    v_mov_b32 v32, 0
    v_mov_b32 v33, 0
    v_mov_b32 v34, 0
    v_mov_b32 v35, 0
    v_mov_b32 v36, 0
    v_mov_b32 v37, 0
    v_mov_b32 v38, 0
    v_mov_b32 v39, 0
    v_and_b32 v11, 31, v6
    v_lshlrev_b32 v11, 2, v11
    s_mul_i32 s40, s33, 768
    s_add_u32 s40, s40, 65536
    v_add_u32 v11, s40, v11
    v_add_u32 v10, 73728, v9
    s_call_b64 s[64:65], tail_cs4
    v_and_b32 v9, 255, v0
    v_lshlrev_b32 v10, 3, v9
    v_lshlrev_b32 v9, 2, v9
    v_add_u32 v9, 155648, v9
    s_mul_i32 s50, s43, 12288
    s_add_u32 s50, s50, 11206656
    s_mul_i32 s51, s34, 1536
    s_add_u32 s51, s51, s50
    s_and_b32 s40, s35, 1
    s_lshl_b32 s40, s40, 2
    s_or_b32 s40, s40, s33
    s_cmp_lt_u32 s40, 3
    s_cselect_b32 s51, s51, 0x40000000
    ds_write_b32 v11, v16 offset:0
    ds_write_b32 v11, v20 offset:128
    ds_write_b32 v11, v24 offset:256
    ds_write_b32 v11, v28 offset:384
    ds_write_b32 v11, v32 offset:512
    ds_write_b32 v11, v36 offset:640
    s_waitcnt lgkmcnt(0)
    s_barrier
    v_add_u32 v11, 0xfffea000, v9
    ds_read_b32 v16, v11 offset:0
    ds_read_b32 v18, v11 offset:768
    ds_read_b32 v20, v11 offset:1536
    ds_read_b32 v22, v11 offset:2304
    v_mov_b32 v17, s39
    s_add_u32 m0, s48, 0
    s_call_b64 s[64:65], tail_w4
    s_add_u32 m0, s48, 24576
    s_call_b64 s[64:65], tail_w4
    s_waitcnt lgkmcnt(0)
    v_add_f32 v16, v16, v18
    v_add_f32 v20, v20, v22
    v_add_f32 v16, v16, v20
    buffer_store_dwordx2 v[16:17], v10, s[20:23], s51 offen sc0 sc1
    s_barrier
    s_add_u32 m0, s48, 49152
    s_call_b64 s[64:65], tail_w4
    s_waitcnt vmcnt(0)
    s_barrier
    s_barrier
    s_mov_b32 s51, 0
tail_gat:
    s_mov_b32 s40, s50
    buffer_load_dwordx2 v[40:41], v10, s[20:23], s40 offen offset:0 sc1
    buffer_load_dwordx2 v[42:43], v10, s[20:23], s40 offen offset:1536 sc1
    s_add_u32 s40, s40, 3072
    buffer_load_dwordx2 v[44:45], v10, s[20:23], s40 offen offset:0 sc1
    buffer_load_dwordx2 v[46:47], v10, s[20:23], s40 offen offset:1536 sc1
    s_add_u32 s40, s40, 3072
    buffer_load_dwordx2 v[48:49], v10, s[20:23], s40 offen offset:0 sc1
    buffer_load_dwordx2 v[50:51], v10, s[20:23], s40 offen offset:1536 sc1
    s_add_u32 s40, s40, 3072
    buffer_load_dwordx2 v[52:53], v10, s[20:23], s40 offen offset:0 sc1
    buffer_load_dwordx2 v[54:55], v10, s[20:23], s40 offen offset:1536 sc1
    s_add_u32 s40, s40, 3072
    s_cmp_lg_u32 s51, 0
    s_cbranch_scc1 tail_gat1
    s_add_u32 m0, s48, 73728
    s_call_b64 s[64:65], tail_w4
    s_add_u32 m0, s48, 98304
    s_call_b64 s[64:65], tail_w4
    s_lshl_b32 s49, s34, 3
    s_and_b32 s40, s35, 1
    s_lshl_b32 s40, s40, 2
    s_add_u32 s49, s49, s40
    s_add_u32 s49, s49, s33
    s_mul_i32 s49, s49, 88
    s_mul_i32 s40, s43, 6
    s_add_u32 s49, s49, s40
    s_lshl_b32 s49, s49, 10
    s_add_u32 s49, s49, 11534336
    v_min_u32 v7, 47, v6
    v_lshlrev_b32 v7, 7, v7
    buffer_load_dword v109, v7, s[20:23], s49 offen
    s_waitcnt vmcnt(13)
    s_branch tail_gat1b
tail_gat1:
    s_waitcnt vmcnt(0)
tail_gat1b:
    s_add_u32 s51, s51, 1
    s_cmp_eq_u32 s33, 3
    s_cbranch_scc1 tail_gat3
    v_xor_b32 v7, s39, v41
    v_xor_b32 v5, s39, v43
    v_or_b32 v7, v7, v5
    v_add_f32 v40, v40, v42
    v_xor_b32 v5, s39, v45
    v_or_b32 v7, v7, v5
    v_add_f32 v40, v40, v44
    v_xor_b32 v5, s39, v47
    v_or_b32 v7, v7, v5
    v_add_f32 v40, v40, v46
    v_xor_b32 v5, s39, v49
    v_or_b32 v7, v7, v5
    v_add_f32 v40, v40, v48
    v_xor_b32 v5, s39, v51
    v_or_b32 v7, v7, v5
    v_add_f32 v40, v40, v50
    v_xor_b32 v5, s39, v53
    v_or_b32 v7, v7, v5
    v_add_f32 v40, v40, v52
    v_xor_b32 v5, s39, v55
    v_or_b32 v7, v7, v5
    v_add_f32 v40, v40, v54
    v_cmp_ne_u32 vcc, 0, v7
    s_cmp_gt_u32 s51, 200000
    s_cbranch_scc1 tail_gat2
    s_cbranch_vccnz tail_gat
tail_gat2:
    ds_write_b32 v9, v40 offset:4096
    s_waitcnt lgkmcnt(0)
tail_gat3:
    s_add_u32 s53, s45, 122880
    s_add_u32 s54, s52, 983040
    s_mov_b32 s55, 4
    s_call_b64 s[64:65], tail_w5
    s_waitcnt vmcnt(9)
    s_barrier
    s_add_u32 s53, s45, 0
    s_add_u32 s54, s52, 0
    s_mov_b32 s55, 9
    s_call_b64 s[64:65], tail_w5
    s_barrier
    s_add_u32 s53, s45, 73728
    s_add_u32 s54, s52, 589824
    s_mov_b32 s55, 6
    s_call_b64 s[64:65], tail_w5
    s_mov_b32 s63, 0
    s_branch tail_h5
tail_hidle:
    s_add_u32 s53, s45, 65536
    s_add_u32 s54, s52, 524288
    s_mov_b32 s55, 6
    s_call_b64 s[64:65], tail_w5
    s_barrier
    s_add_u32 s53, s45, 0
    s_add_u32 s54, s52, 0
    s_mov_b32 s55, 8
    s_call_b64 s[64:65], tail_w5
    s_barrier
    s_cmp_lg_u32 s2, 248
    s_cbranch_scc1 tail_noep
    v_mov_b32 v5, s39
    v_mov_b32 v7, 0
    s_mov_b32 s40, 11075584
    s_mov_b64 exec, 1
    buffer_store_dword v5, v7, s[20:23], s40 offen sc0 sc1
    s_mov_b64 exec, -1
tail_noep:
    s_add_u32 s53, s45, 114688
    s_add_u32 s54, s52, 917504
    s_mov_b32 s55, 4
    s_call_b64 s[64:65], tail_w5
    s_barrier
    s_add_u32 s53, s45, 147456
    s_add_u32 s54, s52, 1179648
    s_mov_b32 s55, 1
    s_call_b64 s[64:65], tail_w5
    s_mov_b32 s63, 0
tail_h5:
    s_waitcnt vmcnt(0)
    s_barrier
    s_barrier
    s_add_u32 s53, s45, 155648
    s_add_u32 s54, s52, 1245184
    s_mov_b32 s55, 1
    s_call_b64 s[64:65], tail_w5
    s_add_u32 s53, s45, 0
    s_add_u32 s54, s52, 1310720
    s_mov_b32 s55, 2
    s_call_b64 s[64:65], tail_w5
    s_waitcnt vmcnt(0)
    s_barrier
    s_endpgm
tail_w4:
    buffer_load_dwordx4 v115, s[24:27], s47 offen offset:0 lds
    s_add_u32 m0, m0, 4032
    s_nop 0
    buffer_load_dwordx4 v115, s[24:27], s47 offen offset:64 lds
    s_add_u32 m0, m0, 4032
    s_nop 0
    buffer_load_dwordx4 v115, s[24:27], s47 offen offset:128 lds
    s_add_u32 m0, m0, 4224
    s_nop 0
    buffer_load_dwordx4 v115, s[28:31], s47 offen offset:0 lds
    s_add_u32 m0, m0, 4032
    s_nop 0
    buffer_load_dwordx4 v115, s[28:31], s47 offen offset:64 lds
    s_add_u32 m0, m0, 4032
    s_nop 0
    buffer_load_dwordx4 v115, s[28:31], s47 offen offset:128 lds
    s_nop 0
    s_add_u32 s47, s47, 176128
    s_cmp_eq_u32 s47, s46
    s_cselect_b32 s40, 1409024, 0
    s_sub_u32 s47, s47, s40
    s_setpc_b64 s[64:65]
tail_cs4:
    ds_read_b64_tr_b16 v[40:41], v10 offset:0
    ds_read_b64_tr_b16 v[42:43], v10 offset:512
    ds_read_b64_tr_b16 v[44:45], v10 offset:4096
    ds_read_b64_tr_b16 v[46:47], v10 offset:4608
    ds_read_b64_tr_b16 v[48:49], v10 offset:8192
    ds_read_b64_tr_b16 v[50:51], v10 offset:8704
    ds_read_b64_tr_b16 v[52:53], v10 offset:12288
    ds_read_b64_tr_b16 v[54:55], v10 offset:12800
    ds_read_b64_tr_b16 v[56:57], v10 offset:16384
    ds_read_b64_tr_b16 v[58:59], v10 offset:16896
    ds_read_b64_tr_b16 v[60:61], v10 offset:20480
    ds_read_b64_tr_b16 v[62:63], v10 offset:20992
    s_waitcnt lgkmcnt(10)
    v_mfma_f32_16x16x32_bf16 v[16:19], v[12:15], v[40:43], v[16:19]
    s_waitcnt lgkmcnt(8)
    v_mfma_f32_16x16x32_bf16 v[20:23], v[12:15], v[44:47], v[20:23]
    s_waitcnt lgkmcnt(6)
    v_mfma_f32_16x16x32_bf16 v[24:27], v[12:15], v[48:51], v[24:27]
    s_waitcnt lgkmcnt(4)
    v_mfma_f32_16x16x32_bf16 v[28:31], v[12:15], v[52:55], v[28:31]
    s_waitcnt lgkmcnt(2)
    v_mfma_f32_16x16x32_bf16 v[32:35], v[12:15], v[56:59], v[32:35]
    s_waitcnt lgkmcnt(0)
    v_mfma_f32_16x16x32_bf16 v[36:39], v[12:15], v[60:63], v[36:39]
    s_setpc_b64 s[64:65]
tail_w5:
    s_mov_b32 m0, s53
    s_add_u32 s53, s53, 8192
    buffer_load_dwordx4 v112, s[56:59], s54 offen lds
    buffer_load_dwordx4 v8, s[56:59], s54 offen offset:1024 lds
    s_add_u32 s54, s54, 0x10000
    s_sub_u32 s55, s55, 1
    s_cmp_lg_u32 s55, 0
    s_cbranch_scc1 tail_w5
    s_setpc_b64 s[64:65]
tail_comp:
    s_and_b32 s41, s35, 3
    s_lshl_b32 s42, s34, 2
    s_add_u32 s41, s41, s42
    s_lshr_b32 s42, s35, 2
    s_lshr_b32 s43, s35, 1
    s_and_b32 s44, s33, 1
    s_lshr_b32 s45, s33, 1
    s_lshl_b32 s46, s41, 1
    s_add_u32 s46, s46, s44
    v_bfe_u32 v7, v6, 2, 2
    v_lshrrev_b32 v5, 5, v6
    v_lshl_add_u32 v5, v5, 2, v7
    v_lshlrev_b32 v2, 7, v5
    v_lshrrev_b32 v7, 1, v7
    v_lshl_add_u32 v2, v7, 6, v2
    v_bfe_u32 v7, v6, 4, 1
    v_and_b32 v5, 3, v6
    v_lshl_add_u32 v7, v7, 2, v5
    v_lshl_add_u32 v2, v7, 3, v2
    s_lshl_b32 s40, s45, 11
    v_add_u32 v2, s40, v2
    v_xor_b32 v3, 64, v2
    ds_read_b64_tr_b16 v[72:73], v2 offset:0
    ds_read_b64_tr_b16 v[74:75], v2 offset:1024
    ds_read_b64_tr_b16 v[76:77], v3 offset:0
    ds_read_b64_tr_b16 v[78:79], v3 offset:1024
    ds_read_b64_tr_b16 v[80:81], v2 offset:4096
    ds_read_b64_tr_b16 v[82:83], v2 offset:5120
    ds_read_b64_tr_b16 v[84:85], v3 offset:4096
    ds_read_b64_tr_b16 v[86:87], v3 offset:5120
    ds_read_b64_tr_b16 v[88:89], v2 offset:8192
    ds_read_b64_tr_b16 v[90:91], v2 offset:9216
    ds_read_b64_tr_b16 v[92:93], v3 offset:8192
    ds_read_b64_tr_b16 v[94:95], v3 offset:9216
    ds_read_b64_tr_b16 v[96:97], v2 offset:12288
    ds_read_b64_tr_b16 v[98:99], v2 offset:13312
    ds_read_b64_tr_b16 v[100:101], v3 offset:12288
    ds_read_b64_tr_b16 v[102:103], v3 offset:13312
    ds_read_b64_tr_b16 v[104:105], v2 offset:16384
    ds_read_b64_tr_b16 v[106:107], v2 offset:17408
    ds_read_b64_tr_b16 v[108:109], v3 offset:16384
    ds_read_b64_tr_b16 v[110:111], v3 offset:17408
    ds_read_b64_tr_b16 v[112:113], v2 offset:20480
    ds_read_b64_tr_b16 v[114:115], v2 offset:21504
    ds_read_b64_tr_b16 v[116:117], v3 offset:20480
    ds_read_b64_tr_b16 v[118:119], v3 offset:21504
    ds_read_b64_tr_b16 v[120:121], v2 offset:24576
    ds_read_b64_tr_b16 v[122:123], v2 offset:25600
    ds_read_b64_tr_b16 v[124:125], v3 offset:24576
    ds_read_b64_tr_b16 v[126:127], v3 offset:25600
    ds_read_b64_tr_b16 v[128:129], v2 offset:28672
    ds_read_b64_tr_b16 v[130:131], v2 offset:29696
    ds_read_b64_tr_b16 v[132:133], v3 offset:28672
    ds_read_b64_tr_b16 v[134:135], v3 offset:29696
    ds_read_b64_tr_b16 v[136:137], v2 offset:32768
    ds_read_b64_tr_b16 v[138:139], v2 offset:33792
    ds_read_b64_tr_b16 v[140:141], v3 offset:32768
    ds_read_b64_tr_b16 v[142:143], v3 offset:33792
    ds_read_b64_tr_b16 v[144:145], v2 offset:36864
    ds_read_b64_tr_b16 v[146:147], v2 offset:37888
    ds_read_b64_tr_b16 v[148:149], v3 offset:36864
    ds_read_b64_tr_b16 v[150:151], v3 offset:37888
    ds_read_b64_tr_b16 v[152:153], v2 offset:40960
    ds_read_b64_tr_b16 v[154:155], v2 offset:41984
    ds_read_b64_tr_b16 v[156:157], v3 offset:40960
    ds_read_b64_tr_b16 v[158:159], v3 offset:41984
    ds_read_b64_tr_b16 v[160:161], v2 offset:45056
    ds_read_b64_tr_b16 v[162:163], v2 offset:46080
    ds_read_b64_tr_b16 v[164:165], v3 offset:45056
    ds_read_b64_tr_b16 v[166:167], v3 offset:46080
    ds_read_b64_tr_b16 v[168:169], v2 offset:49152
    ds_read_b64_tr_b16 v[170:171], v2 offset:50176
    ds_read_b64_tr_b16 v[172:173], v3 offset:49152
    ds_read_b64_tr_b16 v[174:175], v3 offset:50176
    ds_read_b64_tr_b16 v[176:177], v2 offset:53248
    ds_read_b64_tr_b16 v[178:179], v2 offset:54272
    ds_read_b64_tr_b16 v[180:181], v3 offset:53248
    ds_read_b64_tr_b16 v[182:183], v3 offset:54272
    ds_read_b64_tr_b16 v[184:185], v2 offset:57344
    ds_read_b64_tr_b16 v[186:187], v2 offset:58368
    ds_read_b64_tr_b16 v[188:189], v3 offset:57344
    ds_read_b64_tr_b16 v[190:191], v3 offset:58368
    ds_read_b64_tr_b16 v[192:193], v2 offset:61440
    ds_read_b64_tr_b16 v[194:195], v2 offset:62464
    ds_read_b64_tr_b16 v[196:197], v3 offset:61440
    ds_read_b64_tr_b16 v[198:199], v3 offset:62464
    s_lshl_b32 s49, s46, 10
    s_lshl_b32 s40, s45, 16
    s_add_u32 s49, s49, s40
    s_add_u32 s49, s49, 6291456
    s_lshl_b32 s47, s42, 2
    s_lshl_b32 s40, s45, 1
    s_add_u32 s47, s47, s40
    s_lshl_b32 s47, s47, 10
    s_lshl_b32 s40, s46, 15
    s_add_u32 s47, s47, s40
    s_add_u32 s47, s47, 8388608
    s_lshl_b32 s48, s46, 12
    s_lshl_b32 s40, s42, 9
    s_add_u32 s48, s48, s40
    s_lshl_b32 s40, s45, 8
    s_add_u32 s48, s48, s40
    s_add_u32 s48, s48, 10485760
    s_lshl_b32 s53, s34, 3
    s_and_b32 s40, s35, 1
    s_lshl_b32 s40, s40, 2
    s_add_u32 s53, s53, s40
    s_add_u32 s53, s53, s33
    s_mul_i32 s50, s53, 88
    s_mul_i32 s40, s43, 6
    s_add_u32 s50, s50, s40
    s_lshl_b32 s50, s50, 10
    s_add_u32 s50, s50, 11534336
    s_lshl_b32 s54, s53, 15
    s_add_u32 s54, s54, 8388608
    s_add_u32 s60, s54, 32768
    s_lshl_b32 s40, s34, 12
    s_add_u32 s54, s54, s40
    s_lshl_b32 s55, s53, 12
    s_add_u32 s55, s55, 10485760
    s_mov_b32 s56, 0x3b000000
    s_mov_b32 s57, 0x3727c5ac
    s_mov_b32 s58, 0xbfb8aa3b
    s_lshl_b32 s59, s46, 7
    s_add_u32 s59, s59, 11026432
    s_waitcnt lgkmcnt(0)
    s_barrier
    v_and_b32 v7, 31, v6
    v_lshlrev_b32 v7, 2, v7
    s_mov_b32 s40, 0
tail_p1:
    buffer_load_dword v200, v7, s[20:23], s59 offen offset:0 sc1
    s_add_u32 s40, s40, 1
    s_cmp_gt_u32 s40, 200000
    s_cbranch_scc1 tail_p1_x
    s_waitcnt vmcnt(0)
    v_cmp_ne_u32 vcc, s39, v200
    s_cbranch_vccnz tail_p1
tail_p1_x:
    buffer_load_dwordx4 v[8:11], v1, s[20:23], s49 offen sc1
    s_add_u32 s49, s49, 0x20000
    buffer_load_dwordx4 v[12:15], v1, s[20:23], s49 offen sc1
    s_add_u32 s49, s49, 0x20000
    buffer_load_dwordx4 v[16:19], v1, s[20:23], s49 offen sc1
    s_add_u32 s49, s49, 0x20000
    buffer_load_dwordx4 v[20:23], v1, s[20:23], s49 offen sc1
    s_add_u32 s49, s49, 0x20000
    buffer_load_dwordx4 v[24:27], v1, s[20:23], s49 offen sc1
    s_add_u32 s49, s49, 0x20000
    buffer_load_dwordx4 v[28:31], v1, s[20:23], s49 offen sc1
    s_add_u32 s49, s49, 0x20000
    buffer_load_dwordx4 v[32:35], v1, s[20:23], s49 offen sc1
    s_add_u32 s49, s49, 0x20000
    buffer_load_dwordx4 v[36:39], v1, s[20:23], s49 offen sc1
    s_add_u32 s49, s49, 0x20000
    buffer_load_dwordx4 v[40:43], v1, s[20:23], s49 offen sc1
    s_add_u32 s49, s49, 0x20000
    buffer_load_dwordx4 v[44:47], v1, s[20:23], s49 offen sc1
    s_add_u32 s49, s49, 0x20000
    buffer_load_dwordx4 v[48:51], v1, s[20:23], s49 offen sc1
    s_add_u32 s49, s49, 0x20000
    buffer_load_dwordx4 v[52:55], v1, s[20:23], s49 offen sc1
    s_add_u32 s49, s49, 0x20000
    buffer_load_dwordx4 v[56:59], v1, s[20:23], s49 offen sc1
    s_add_u32 s49, s49, 0x20000
    buffer_load_dwordx4 v[60:63], v1, s[20:23], s49 offen sc1
    s_add_u32 s49, s49, 0x20000
    buffer_load_dwordx4 v[64:67], v1, s[20:23], s49 offen sc1
    s_add_u32 s49, s49, 0x20000
    buffer_load_dwordx4 v[68:71], v1, s[20:23], s49 offen sc1
    s_add_u32 s49, s49, 0x20000
    s_waitcnt vmcnt(15)
    v_mfma_f32_32x32x16_bf16 v[224:239], v[72:75], v[8:11], 0
    v_mfma_f32_32x32x16_bf16 v[240:255], v[76:79], v[8:11], 0
    s_waitcnt vmcnt(14)
    v_mfma_f32_32x32x16_bf16 v[224:239], v[80:83], v[12:15], v[224:239]
    v_mfma_f32_32x32x16_bf16 v[240:255], v[84:87], v[12:15], v[240:255]
    s_waitcnt vmcnt(13)
    v_mfma_f32_32x32x16_bf16 v[224:239], v[88:91], v[16:19], v[224:239]
    v_mfma_f32_32x32x16_bf16 v[240:255], v[92:95], v[16:19], v[240:255]
    s_waitcnt vmcnt(12)
    v_mfma_f32_32x32x16_bf16 v[224:239], v[96:99], v[20:23], v[224:239]
    v_mfma_f32_32x32x16_bf16 v[240:255], v[100:103], v[20:23], v[240:255]
    s_waitcnt vmcnt(11)
    v_mfma_f32_32x32x16_bf16 v[224:239], v[104:107], v[24:27], v[224:239]
    v_mfma_f32_32x32x16_bf16 v[240:255], v[108:111], v[24:27], v[240:255]
    s_waitcnt vmcnt(10)
    v_mfma_f32_32x32x16_bf16 v[224:239], v[112:115], v[28:31], v[224:239]
    v_mfma_f32_32x32x16_bf16 v[240:255], v[116:119], v[28:31], v[240:255]
    s_waitcnt vmcnt(9)
    v_mfma_f32_32x32x16_bf16 v[224:239], v[120:123], v[32:35], v[224:239]
    v_mfma_f32_32x32x16_bf16 v[240:255], v[124:127], v[32:35], v[240:255]
    s_waitcnt vmcnt(8)
    v_mfma_f32_32x32x16_bf16 v[224:239], v[128:131], v[36:39], v[224:239]
    v_mfma_f32_32x32x16_bf16 v[240:255], v[132:135], v[36:39], v[240:255]
    s_waitcnt vmcnt(7)
    v_mfma_f32_32x32x16_bf16 v[224:239], v[136:139], v[40:43], v[224:239]
    v_mfma_f32_32x32x16_bf16 v[240:255], v[140:143], v[40:43], v[240:255]
    s_waitcnt vmcnt(6)
    v_mfma_f32_32x32x16_bf16 v[224:239], v[144:147], v[44:47], v[224:239]
    v_mfma_f32_32x32x16_bf16 v[240:255], v[148:151], v[44:47], v[240:255]
    s_waitcnt vmcnt(5)
    v_mfma_f32_32x32x16_bf16 v[224:239], v[152:155], v[48:51], v[224:239]
    v_mfma_f32_32x32x16_bf16 v[240:255], v[156:159], v[48:51], v[240:255]
    s_waitcnt vmcnt(4)
    v_mfma_f32_32x32x16_bf16 v[224:239], v[160:163], v[52:55], v[224:239]
    v_mfma_f32_32x32x16_bf16 v[240:255], v[164:167], v[52:55], v[240:255]
    s_waitcnt vmcnt(3)
    v_mfma_f32_32x32x16_bf16 v[224:239], v[168:171], v[56:59], v[224:239]
    v_mfma_f32_32x32x16_bf16 v[240:255], v[172:175], v[56:59], v[240:255]
    s_waitcnt vmcnt(2)
    v_mfma_f32_32x32x16_bf16 v[224:239], v[176:179], v[60:63], v[224:239]
    v_mfma_f32_32x32x16_bf16 v[240:255], v[180:183], v[60:63], v[240:255]
    s_waitcnt vmcnt(1)
    v_mfma_f32_32x32x16_bf16 v[224:239], v[184:187], v[64:67], v[224:239]
    v_mfma_f32_32x32x16_bf16 v[240:255], v[188:191], v[64:67], v[240:255]
    s_waitcnt vmcnt(0)
    v_mfma_f32_32x32x16_bf16 v[224:239], v[192:195], v[68:71], v[224:239]
    v_mfma_f32_32x32x16_bf16 v[240:255], v[196:199], v[68:71], v[240:255]
    s_xor_b32 s40, s33, 2
    s_lshl_b32 s40, s40, 12
    s_add_u32 s40, s40, 147456
    v_add_u32 v7, s40, v1
    s_lshl_b32 s40, s33, 12
    s_add_u32 s40, s40, 147456
    v_add_u32 v5, s40, v1
    s_nop 4
    s_cmp_eq_u32 s45, 0
    s_cbranch_scc1 tail_x30
    ds_write_b128 v7, v[224:227] offset:0
    ds_write_b128 v7, v[228:231] offset:1024
    ds_write_b128 v7, v[232:235] offset:2048
    ds_write_b128 v7, v[236:239] offset:3072
    s_waitcnt lgkmcnt(0)
    v_pk_mov_b32 v[224:225], v[240:241], v[240:241] op_sel:[0,1]
    v_pk_mov_b32 v[226:227], v[242:243], v[242:243] op_sel:[0,1]
    v_pk_mov_b32 v[228:229], v[244:245], v[244:245] op_sel:[0,1]
    v_pk_mov_b32 v[230:231], v[246:247], v[246:247] op_sel:[0,1]
    v_pk_mov_b32 v[232:233], v[248:249], v[248:249] op_sel:[0,1]
    v_pk_mov_b32 v[234:235], v[250:251], v[250:251] op_sel:[0,1]
    v_pk_mov_b32 v[236:237], v[252:253], v[252:253] op_sel:[0,1]
    v_pk_mov_b32 v[238:239], v[254:255], v[254:255] op_sel:[0,1]
    s_branch tail_x31
tail_x30:
    ds_write_b128 v7, v[240:243] offset:0
    ds_write_b128 v7, v[244:247] offset:1024
    ds_write_b128 v7, v[248:251] offset:2048
    ds_write_b128 v7, v[252:255] offset:3072
    s_waitcnt lgkmcnt(0)
tail_x31:
    s_barrier
    ds_read_b128 v[240:243], v5 offset:0
    ds_read_b128 v[244:247], v5 offset:1024
    ds_read_b128 v[248:251], v5 offset:2048
    ds_read_b128 v[252:255], v5 offset:3072
    v_lshlrev_b32 v8, 16, v216
    v_and_b32 v9, 0xffff0000, v216
    v_lshlrev_b32 v10, 16, v217
    v_and_b32 v11, 0xffff0000, v217
    v_lshlrev_b32 v12, 16, v218
    v_and_b32 v13, 0xffff0000, v218
    v_lshlrev_b32 v14, 16, v219
    v_and_b32 v15, 0xffff0000, v219
    v_lshlrev_b32 v16, 16, v220
    v_and_b32 v17, 0xffff0000, v220
    v_lshlrev_b32 v18, 16, v221
    v_and_b32 v19, 0xffff0000, v221
    v_lshlrev_b32 v20, 16, v222
    v_and_b32 v21, 0xffff0000, v222
    v_lshlrev_b32 v22, 16, v223
    v_and_b32 v23, 0xffff0000, v223
    v_pk_add_f32 v[8:9], v[8:9], v[224:225]
    v_pk_add_f32 v[10:11], v[10:11], v[226:227]
    v_pk_add_f32 v[12:13], v[12:13], v[228:229]
    v_pk_add_f32 v[14:15], v[14:15], v[230:231]
    v_pk_add_f32 v[16:17], v[16:17], v[232:233]
    v_pk_add_f32 v[18:19], v[18:19], v[234:235]
    v_pk_add_f32 v[20:21], v[20:21], v[236:237]
    v_pk_add_f32 v[22:23], v[22:23], v[238:239]
    s_waitcnt lgkmcnt(0)
    v_pk_add_f32 v[8:9], v[8:9], v[240:241]
    v_pk_add_f32 v[10:11], v[10:11], v[242:243]
    v_pk_add_f32 v[12:13], v[12:13], v[244:245]
    v_pk_add_f32 v[14:15], v[14:15], v[246:247]
    v_pk_add_f32 v[16:17], v[16:17], v[248:249]
    v_pk_add_f32 v[18:19], v[18:19], v[250:251]
    v_pk_add_f32 v[20:21], v[20:21], v[252:253]
    v_pk_add_f32 v[22:23], v[22:23], v[254:255]
    v_cvt_pk_bf16_f32 v216, v8, v9
    v_cvt_pk_bf16_f32 v217, v10, v11
    v_cvt_pk_bf16_f32 v218, v12, v13
    v_cvt_pk_bf16_f32 v219, v14, v15
    v_cvt_pk_bf16_f32 v220, v16, v17
    v_cvt_pk_bf16_f32 v221, v18, v19
    v_cvt_pk_bf16_f32 v222, v20, v21
    v_cvt_pk_bf16_f32 v223, v22, v23
    s_cmp_lg_u32 s36, 0
    s_cbranch_scc1 tail_sh_d
    buffer_store_dwordx4 v[216:219], v1, s[20:23], s47 offen offset:0
    buffer_store_dwordx4 v[220:223], v1, s[20:23], s47 offen offset:1024
    s_branch tail_sh_e
tail_sh_d:
    buffer_store_dwordx4 v[216:219], v1, s[20:23], s47 offen offset:0 sc0 sc1
    buffer_store_dwordx4 v[220:223], v1, s[20:23], s47 offen offset:1024 sc0 sc1
tail_sh_e:
    v_lshlrev_b32 v8, 16, v216
    v_and_b32 v9, 0xffff0000, v216
    v_lshlrev_b32 v10, 16, v217
    v_and_b32 v11, 0xffff0000, v217
    v_lshlrev_b32 v12, 16, v218
    v_and_b32 v13, 0xffff0000, v218
    v_lshlrev_b32 v14, 16, v219
    v_and_b32 v15, 0xffff0000, v219
    v_lshlrev_b32 v16, 16, v220
    v_and_b32 v17, 0xffff0000, v220
    v_lshlrev_b32 v18, 16, v221
    v_and_b32 v19, 0xffff0000, v221
    v_lshlrev_b32 v20, 16, v222
    v_and_b32 v21, 0xffff0000, v222
    v_lshlrev_b32 v22, 16, v223
    v_and_b32 v23, 0xffff0000, v223
    v_pk_add_f32 v[24:25], v[8:9], v[10:11]
    v_pk_mul_f32 v[26:27], v[8:9], v[8:9]
    v_pk_fma_f32 v[26:27], v[10:11], v[10:11], v[26:27]
    v_pk_add_f32 v[24:25], v[24:25], v[12:13]
    v_pk_fma_f32 v[26:27], v[12:13], v[12:13], v[26:27]
    v_pk_add_f32 v[24:25], v[24:25], v[14:15]
    v_pk_fma_f32 v[26:27], v[14:15], v[14:15], v[26:27]
    v_pk_add_f32 v[24:25], v[24:25], v[16:17]
    v_pk_fma_f32 v[26:27], v[16:17], v[16:17], v[26:27]
    v_pk_add_f32 v[24:25], v[24:25], v[18:19]
    v_pk_fma_f32 v[26:27], v[18:19], v[18:19], v[26:27]
    v_pk_add_f32 v[24:25], v[24:25], v[20:21]
    v_pk_fma_f32 v[26:27], v[20:21], v[20:21], v[26:27]
    v_pk_add_f32 v[24:25], v[24:25], v[22:23]
    v_pk_fma_f32 v[26:27], v[22:23], v[22:23], v[26:27]
    v_add_f32 v24, v24, v25
    v_add_f32 v25, v26, v27
    v_mov_b32 v26, v24
    v_mov_b32 v27, v25
    v_and_b32 v2, 31, v6
    v_lshlrev_b32 v2, 3, v2
    v_permlane32_swap_b32 v24, v26
    v_permlane32_swap_b32 v25, v27
    s_nop 1
    v_pk_add_f32 v[24:25], v[24:25], v[26:27]
    s_mov_b32 exec_hi, 0
    s_cmp_lg_u32 s36, 0
    s_cbranch_scc1 tail_ss_d
    buffer_store_dwordx2 v[24:25], v2, s[20:23], s48 offen
    s_branch tail_ss_e
tail_ss_d:
    buffer_store_dwordx2 v[24:25], v2, s[20:23], s48 offen sc0 sc1
tail_ss_e:
    s_mov_b32 exec_hi, -1
    s_and_b32 s61, s46, 7
    s_lshl_b32 s61, s61, 4
    s_lshl_b32 s62, s42, 1
    s_add_u32 s62, s62, s45
    s_add_u32 s62, s62, s61
    s_lshl_b32 s40, s62, 2
    s_add_u32 s40, s40, s37
    v_mov_b32 v7, 0
    v_mov_b32 v5, s39
    s_mov_b64 exec, 1
    s_waitcnt vmcnt(0)
    s_cmp_lg_u32 s36, 0
    s_cbranch_scc1 tail_f2_d
    buffer_store_dword v5, v7, s[20:23], s40 offen offset:1024
    s_branch tail_f2_e
tail_f2_d:
    buffer_store_dword v5, v7, s[20:23], s40 offen offset:1024 sc0 sc1
tail_f2_e:
    s_mov_b64 exec, -1
    s_cmp_lt_u32 s43, 15
    s_cbranch_scc1 tail_c4go
    s_barrier
    s_branch tail_c4done
tail_c4go:
    v_lshrrev_b32 v5, 5, v6
    v_lshl_add_u32 v4, v5, 11, v2
    s_and_b32 s62, s53, 7
    s_lshl_b32 s62, s62, 6
    s_add_u32 s62, s62, s37
    v_and_b32 v7, 15, v6
    v_lshlrev_b32 v7, 2, v7
    s_mov_b32 s40, 0
tail_p2:
    buffer_load_dword v8, v7, s[20:23], s62 offen offset:1024 sc1
    s_add_u32 s40, s40, 1
    s_cmp_gt_u32 s40, 200000
    s_cbranch_scc1 tail_p2_x
    s_waitcnt vmcnt(0)
    v_cmp_ne_u32 vcc, s39, v8
    s_cbranch_vccnz tail_p2
tail_p2_x:
    buffer_load_dwordx4 v[32:35], v1, s[20:23], s54 offen offset:0 sc1
    buffer_load_dwordx4 v[36:39], v1, s[20:23], s54 offen offset:1024 sc1
    buffer_load_dwordx4 v[40:43], v1, s[20:23], s54 offen offset:2048 sc1
    buffer_load_dwordx4 v[44:47], v1, s[20:23], s54 offen offset:3072 sc1
    s_add_u32 s54, s54, 4096
    s_cmp_eq_u32 s54, s60
    s_cselect_b32 s40, 32768, 0
    s_sub_u32 s54, s54, s40
    buffer_load_dwordx4 v[48:51], v1, s[20:23], s54 offen offset:0 sc1
    buffer_load_dwordx4 v[52:55], v1, s[20:23], s54 offen offset:1024 sc1
    buffer_load_dwordx4 v[56:59], v1, s[20:23], s54 offen offset:2048 sc1
    buffer_load_dwordx4 v[60:63], v1, s[20:23], s54 offen offset:3072 sc1
    s_add_u32 s54, s54, 4096
    s_cmp_eq_u32 s54, s60
    s_cselect_b32 s40, 32768, 0
    s_sub_u32 s54, s54, s40
    buffer_load_dwordx4 v[64:67], v1, s[20:23], s54 offen offset:0 sc1
    buffer_load_dwordx4 v[68:71], v1, s[20:23], s54 offen offset:1024 sc1
    v_bfe_u32 v3, v6, 2, 2
    v_lshl_add_u32 v3, v5, 2, v3
    v_lshlrev_b32 v7, 6, v3
    v_bfe_u32 v3, v6, 4, 1
    v_lshl_add_u32 v7, v3, 5, v7
    v_and_b32 v3, 3, v6
    v_lshl_add_u32 v7, v3, 3, v7
    v_add_u32 v5, 73728, v7
    s_barrier
    ds_read_b64_tr_b16 v[8:9], v5 offset:0
    ds_read_b64_tr_b16 v[10:11], v5 offset:512
    ds_read_b64_tr_b16 v[12:13], v5 offset:4096
    ds_read_b64_tr_b16 v[14:15], v5 offset:4608
    ds_read_b64_tr_b16 v[16:17], v5 offset:8192
    ds_read_b64_tr_b16 v[18:19], v5 offset:8704
    ds_read_b64_tr_b16 v[20:21], v5 offset:12288
    ds_read_b64_tr_b16 v[22:23], v5 offset:12800
    ds_read_b64_tr_b16 v[24:25], v5 offset:16384
    ds_read_b64_tr_b16 v[26:27], v5 offset:16896
    ds_read_b64_tr_b16 v[28:29], v5 offset:20480
    ds_read_b64_tr_b16 v[30:31], v5 offset:20992
    s_waitcnt vmcnt(9) lgkmcnt(8)
    v_mfma_f32_32x32x16_bf16 v[160:175], v[8:11], v[32:35], 0
    ds_read_b64_tr_b16 v[8:9], v5 offset:1024
    ds_read_b64_tr_b16 v[10:11], v5 offset:1536
    v_mfma_f32_32x32x16_bf16 v[176:191], v[12:15], v[32:35], 0
    ds_read_b64_tr_b16 v[12:13], v5 offset:5120
    ds_read_b64_tr_b16 v[14:15], v5 offset:5632
    buffer_load_dwordx4 v[72:75], v1, s[20:23], s54 offen offset:2048 sc1
    s_waitcnt lgkmcnt(8)
    v_mfma_f32_32x32x16_bf16 v[192:207], v[16:19], v[32:35], 0
    ds_read_b64_tr_b16 v[16:17], v5 offset:9216
    ds_read_b64_tr_b16 v[18:19], v5 offset:9728
    v_mfma_f32_32x32x16_bf16 v[208:223], v[20:23], v[32:35], 0
    ds_read_b64_tr_b16 v[20:21], v5 offset:13312
    ds_read_b64_tr_b16 v[22:23], v5 offset:13824
    buffer_load_dwordx4 v[76:79], v1, s[20:23], s54 offen offset:3072 sc1
    s_add_u32 s54, s54, 4096
    s_cmp_eq_u32 s54, s60
    s_cselect_b32 s40, 32768, 0
    s_sub_u32 s54, s54, s40
    s_waitcnt lgkmcnt(8)
    v_mfma_f32_32x32x16_bf16 v[224:239], v[24:27], v[32:35], 0
    ds_read_b64_tr_b16 v[24:25], v5 offset:17408
    ds_read_b64_tr_b16 v[26:27], v5 offset:17920
    v_mfma_f32_32x32x16_bf16 v[240:255], v[28:31], v[32:35], 0
    ds_read_b64_tr_b16 v[28:29], v5 offset:21504
    ds_read_b64_tr_b16 v[30:31], v5 offset:22016
    buffer_load_dwordx4 v[80:83], v1, s[20:23], s54 offen offset:0 sc1
    s_waitcnt vmcnt(11) lgkmcnt(8)
    v_mfma_f32_32x32x16_bf16 v[160:175], v[8:11], v[36:39], v[160:175]
    ds_read_b64_tr_b16 v[8:9], v5 offset:2048
    ds_read_b64_tr_b16 v[10:11], v5 offset:2560
    v_mfma_f32_32x32x16_bf16 v[176:191], v[12:15], v[36:39], v[176:191]
    ds_read_b64_tr_b16 v[12:13], v5 offset:6144
    ds_read_b64_tr_b16 v[14:15], v5 offset:6656
    buffer_load_dwordx4 v[84:87], v1, s[20:23], s54 offen offset:1024 sc1
    s_waitcnt lgkmcnt(8)
    v_mfma_f32_32x32x16_bf16 v[192:207], v[16:19], v[36:39], v[192:207]
    ds_read_b64_tr_b16 v[16:17], v5 offset:10240
    ds_read_b64_tr_b16 v[18:19], v5 offset:10752
    v_mfma_f32_32x32x16_bf16 v[208:223], v[20:23], v[36:39], v[208:223]
    ds_read_b64_tr_b16 v[20:21], v5 offset:14336
    ds_read_b64_tr_b16 v[22:23], v5 offset:14848
    buffer_load_dwordx4 v[88:91], v1, s[20:23], s54 offen offset:2048 sc1
    s_waitcnt lgkmcnt(8)
    v_mfma_f32_32x32x16_bf16 v[224:239], v[24:27], v[36:39], v[224:239]
    ds_read_b64_tr_b16 v[24:25], v5 offset:18432
    ds_read_b64_tr_b16 v[26:27], v5 offset:18944
    v_mfma_f32_32x32x16_bf16 v[240:255], v[28:31], v[36:39], v[240:255]
    ds_read_b64_tr_b16 v[28:29], v5 offset:22528
    ds_read_b64_tr_b16 v[30:31], v5 offset:23040
    buffer_load_dwordx4 v[92:95], v1, s[20:23], s54 offen offset:3072 sc1
    s_add_u32 s54, s54, 4096
    s_cmp_eq_u32 s54, s60
    s_cselect_b32 s40, 32768, 0
    s_sub_u32 s54, s54, s40
    s_waitcnt vmcnt(13) lgkmcnt(8)
    v_mfma_f32_32x32x16_bf16 v[160:175], v[8:11], v[40:43], v[160:175]
    ds_read_b64_tr_b16 v[8:9], v5 offset:3072
    ds_read_b64_tr_b16 v[10:11], v5 offset:3584
    v_mfma_f32_32x32x16_bf16 v[176:191], v[12:15], v[40:43], v[176:191]
    ds_read_b64_tr_b16 v[12:13], v5 offset:7168
    ds_read_b64_tr_b16 v[14:15], v5 offset:7680
    buffer_load_dwordx4 v[96:99], v1, s[20:23], s54 offen offset:0 sc1
    s_waitcnt lgkmcnt(8)
    v_mfma_f32_32x32x16_bf16 v[192:207], v[16:19], v[40:43], v[192:207]
    ds_read_b64_tr_b16 v[16:17], v5 offset:11264
    ds_read_b64_tr_b16 v[18:19], v5 offset:11776
    v_mfma_f32_32x32x16_bf16 v[208:223], v[20:23], v[40:43], v[208:223]
    ds_read_b64_tr_b16 v[20:21], v5 offset:15360
    ds_read_b64_tr_b16 v[22:23], v5 offset:15872
    buffer_load_dwordx4 v[100:103], v1, s[20:23], s54 offen offset:1024 sc1
    s_waitcnt lgkmcnt(8)
    v_mfma_f32_32x32x16_bf16 v[224:239], v[24:27], v[40:43], v[224:239]
    ds_read_b64_tr_b16 v[24:25], v5 offset:19456
    ds_read_b64_tr_b16 v[26:27], v5 offset:19968
    v_mfma_f32_32x32x16_bf16 v[240:255], v[28:31], v[40:43], v[240:255]
    ds_read_b64_tr_b16 v[28:29], v5 offset:23552
    ds_read_b64_tr_b16 v[30:31], v5 offset:24064
    buffer_load_dwordx4 v[104:107], v1, s[20:23], s54 offen offset:2048 sc1
    v_add_u32 v5, 98304, v7
    s_waitcnt vmcnt(15) lgkmcnt(8)
    v_mfma_f32_32x32x16_bf16 v[160:175], v[8:11], v[44:47], v[160:175]
    ds_read_b64_tr_b16 v[8:9], v5 offset:0
    ds_read_b64_tr_b16 v[10:11], v5 offset:512
    v_mfma_f32_32x32x16_bf16 v[176:191], v[12:15], v[44:47], v[176:191]
    ds_read_b64_tr_b16 v[12:13], v5 offset:4096
    ds_read_b64_tr_b16 v[14:15], v5 offset:4608
    buffer_load_dwordx4 v[108:111], v1, s[20:23], s54 offen offset:3072 sc1
    s_add_u32 s54, s54, 4096
    s_cmp_eq_u32 s54, s60
    s_cselect_b32 s40, 32768, 0
    s_sub_u32 s54, s54, s40
    s_waitcnt lgkmcnt(8)
    v_mfma_f32_32x32x16_bf16 v[192:207], v[16:19], v[44:47], v[192:207]
    ds_read_b64_tr_b16 v[16:17], v5 offset:8192
    ds_read_b64_tr_b16 v[18:19], v5 offset:8704
    v_mfma_f32_32x32x16_bf16 v[208:223], v[20:23], v[44:47], v[208:223]
    ds_read_b64_tr_b16 v[20:21], v5 offset:12288
    ds_read_b64_tr_b16 v[22:23], v5 offset:12800
    buffer_load_dwordx4 v[112:115], v1, s[20:23], s54 offen offset:0 sc1
    s_waitcnt lgkmcnt(8)
    v_mfma_f32_32x32x16_bf16 v[224:239], v[24:27], v[44:47], v[224:239]
    ds_read_b64_tr_b16 v[24:25], v5 offset:16384
    ds_read_b64_tr_b16 v[26:27], v5 offset:16896
    v_mfma_f32_32x32x16_bf16 v[240:255], v[28:31], v[44:47], v[240:255]
    ds_read_b64_tr_b16 v[28:29], v5 offset:20480
    ds_read_b64_tr_b16 v[30:31], v5 offset:20992
    buffer_load_dwordx4 v[116:119], v1, s[20:23], s54 offen offset:1024 sc1
    s_waitcnt vmcnt(17) lgkmcnt(8)
    v_mfma_f32_32x32x16_bf16 v[160:175], v[8:11], v[48:51], v[160:175]
    ds_read_b64_tr_b16 v[8:9], v5 offset:1024
    ds_read_b64_tr_b16 v[10:11], v5 offset:1536
    v_mfma_f32_32x32x16_bf16 v[176:191], v[12:15], v[48:51], v[176:191]
    ds_read_b64_tr_b16 v[12:13], v5 offset:5120
    ds_read_b64_tr_b16 v[14:15], v5 offset:5632
    buffer_load_dwordx4 v[120:123], v1, s[20:23], s54 offen offset:2048 sc1
    s_waitcnt lgkmcnt(8)
    v_mfma_f32_32x32x16_bf16 v[192:207], v[16:19], v[48:51], v[192:207]
    ds_read_b64_tr_b16 v[16:17], v5 offset:9216
    ds_read_b64_tr_b16 v[18:19], v5 offset:9728
    v_mfma_f32_32x32x16_bf16 v[208:223], v[20:23], v[48:51], v[208:223]
    ds_read_b64_tr_b16 v[20:21], v5 offset:13312
    ds_read_b64_tr_b16 v[22:23], v5 offset:13824
    buffer_load_dwordx4 v[124:127], v1, s[20:23], s54 offen offset:3072 sc1
    s_add_u32 s54, s54, 4096
    s_cmp_eq_u32 s54, s60
    s_cselect_b32 s40, 32768, 0
    s_sub_u32 s54, s54, s40
    s_waitcnt lgkmcnt(8)
    v_mfma_f32_32x32x16_bf16 v[224:239], v[24:27], v[48:51], v[224:239]
    ds_read_b64_tr_b16 v[24:25], v5 offset:17408
    ds_read_b64_tr_b16 v[26:27], v5 offset:17920
    v_mfma_f32_32x32x16_bf16 v[240:255], v[28:31], v[48:51], v[240:255]
    ds_read_b64_tr_b16 v[28:29], v5 offset:21504
    ds_read_b64_tr_b16 v[30:31], v5 offset:22016
    buffer_load_dwordx4 v[128:131], v1, s[20:23], s54 offen offset:0 sc1
    s_waitcnt vmcnt(19) lgkmcnt(8)
    v_mfma_f32_32x32x16_bf16 v[160:175], v[8:11], v[52:55], v[160:175]
    ds_read_b64_tr_b16 v[8:9], v5 offset:2048
    ds_read_b64_tr_b16 v[10:11], v5 offset:2560
    v_mfma_f32_32x32x16_bf16 v[176:191], v[12:15], v[52:55], v[176:191]
    ds_read_b64_tr_b16 v[12:13], v5 offset:6144
    ds_read_b64_tr_b16 v[14:15], v5 offset:6656
    buffer_load_dwordx4 v[132:135], v1, s[20:23], s54 offen offset:1024 sc1
    s_waitcnt lgkmcnt(8)
    v_mfma_f32_32x32x16_bf16 v[192:207], v[16:19], v[52:55], v[192:207]
    ds_read_b64_tr_b16 v[16:17], v5 offset:10240
    ds_read_b64_tr_b16 v[18:19], v5 offset:10752
    v_mfma_f32_32x32x16_bf16 v[208:223], v[20:23], v[52:55], v[208:223]
    ds_read_b64_tr_b16 v[20:21], v5 offset:14336
    ds_read_b64_tr_b16 v[22:23], v5 offset:14848
    buffer_load_dwordx4 v[136:139], v1, s[20:23], s54 offen offset:2048 sc1
    s_waitcnt lgkmcnt(8)
    v_mfma_f32_32x32x16_bf16 v[224:239], v[24:27], v[52:55], v[224:239]
    ds_read_b64_tr_b16 v[24:25], v5 offset:18432
    ds_read_b64_tr_b16 v[26:27], v5 offset:18944
    v_mfma_f32_32x32x16_bf16 v[240:255], v[28:31], v[52:55], v[240:255]
    ds_read_b64_tr_b16 v[28:29], v5 offset:22528
    ds_read_b64_tr_b16 v[30:31], v5 offset:23040
    buffer_load_dwordx4 v[140:143], v1, s[20:23], s54 offen offset:3072 sc1
    s_add_u32 s54, s54, 4096
    s_cmp_eq_u32 s54, s60
    s_cselect_b32 s40, 32768, 0
    s_sub_u32 s54, s54, s40
    s_waitcnt vmcnt(21) lgkmcnt(8)
    v_mfma_f32_32x32x16_bf16 v[160:175], v[8:11], v[56:59], v[160:175]
    ds_read_b64_tr_b16 v[8:9], v5 offset:3072
    ds_read_b64_tr_b16 v[10:11], v5 offset:3584
    v_mfma_f32_32x32x16_bf16 v[176:191], v[12:15], v[56:59], v[176:191]
    ds_read_b64_tr_b16 v[12:13], v5 offset:7168
    ds_read_b64_tr_b16 v[14:15], v5 offset:7680
    buffer_load_dwordx4 v[144:147], v1, s[20:23], s54 offen offset:0 sc1
    s_waitcnt lgkmcnt(8)
    v_mfma_f32_32x32x16_bf16 v[192:207], v[16:19], v[56:59], v[192:207]
    ds_read_b64_tr_b16 v[16:17], v5 offset:11264
    ds_read_b64_tr_b16 v[18:19], v5 offset:11776
    v_mfma_f32_32x32x16_bf16 v[208:223], v[20:23], v[56:59], v[208:223]
    ds_read_b64_tr_b16 v[20:21], v5 offset:15360
    ds_read_b64_tr_b16 v[22:23], v5 offset:15872
    buffer_load_dwordx4 v[148:151], v1, s[20:23], s54 offen offset:1024 sc1
    s_waitcnt lgkmcnt(8)
    v_mfma_f32_32x32x16_bf16 v[224:239], v[24:27], v[56:59], v[224:239]
    ds_read_b64_tr_b16 v[24:25], v5 offset:19456
    ds_read_b64_tr_b16 v[26:27], v5 offset:19968
    v_mfma_f32_32x32x16_bf16 v[240:255], v[28:31], v[56:59], v[240:255]
    ds_read_b64_tr_b16 v[28:29], v5 offset:23552
    ds_read_b64_tr_b16 v[30:31], v5 offset:24064
    buffer_load_dwordx4 v[152:155], v1, s[20:23], s54 offen offset:2048 sc1
    v_add_u32 v5, 122880, v7
    s_waitcnt vmcnt(23) lgkmcnt(8)
    v_mfma_f32_32x32x16_bf16 v[160:175], v[8:11], v[60:63], v[160:175]
    ds_read_b64_tr_b16 v[8:9], v5 offset:0
    ds_read_b64_tr_b16 v[10:11], v5 offset:512
    v_mfma_f32_32x32x16_bf16 v[176:191], v[12:15], v[60:63], v[176:191]
    ds_read_b64_tr_b16 v[12:13], v5 offset:4096
    ds_read_b64_tr_b16 v[14:15], v5 offset:4608
    buffer_load_dwordx4 v[156:159], v1, s[20:23], s54 offen offset:3072 sc1
    s_waitcnt lgkmcnt(8)
    v_mfma_f32_32x32x16_bf16 v[192:207], v[16:19], v[60:63], v[192:207]
    ds_read_b64_tr_b16 v[16:17], v5 offset:8192
    ds_read_b64_tr_b16 v[18:19], v5 offset:8704
    v_mfma_f32_32x32x16_bf16 v[208:223], v[20:23], v[60:63], v[208:223]
    ds_read_b64_tr_b16 v[20:21], v5 offset:12288
    ds_read_b64_tr_b16 v[22:23], v5 offset:12800
    buffer_load_dwordx2 v[32:33], v4, s[20:23], s55 offen offset:0 sc1
    s_waitcnt lgkmcnt(8)
    v_mfma_f32_32x32x16_bf16 v[224:239], v[24:27], v[60:63], v[224:239]
    ds_read_b64_tr_b16 v[24:25], v5 offset:16384
    ds_read_b64_tr_b16 v[26:27], v5 offset:16896
    v_mfma_f32_32x32x16_bf16 v[240:255], v[28:31], v[60:63], v[240:255]
    ds_read_b64_tr_b16 v[28:29], v5 offset:20480
    ds_read_b64_tr_b16 v[30:31], v5 offset:20992
    buffer_load_dwordx2 v[34:35], v4, s[20:23], s55 offen offset:256 sc1
    s_waitcnt vmcnt(25) lgkmcnt(8)
    v_mfma_f32_32x32x16_bf16 v[160:175], v[8:11], v[64:67], v[160:175]
    ds_read_b64_tr_b16 v[8:9], v5 offset:1024
    ds_read_b64_tr_b16 v[10:11], v5 offset:1536
    v_mfma_f32_32x32x16_bf16 v[176:191], v[12:15], v[64:67], v[176:191]
    ds_read_b64_tr_b16 v[12:13], v5 offset:5120
    ds_read_b64_tr_b16 v[14:15], v5 offset:5632
    buffer_load_dwordx2 v[36:37], v4, s[20:23], s55 offen offset:512 sc1
    s_waitcnt lgkmcnt(8)
    v_mfma_f32_32x32x16_bf16 v[192:207], v[16:19], v[64:67], v[192:207]
    ds_read_b64_tr_b16 v[16:17], v5 offset:9216
    ds_read_b64_tr_b16 v[18:19], v5 offset:9728
    v_mfma_f32_32x32x16_bf16 v[208:223], v[20:23], v[64:67], v[208:223]
    ds_read_b64_tr_b16 v[20:21], v5 offset:13312
    ds_read_b64_tr_b16 v[22:23], v5 offset:13824
    buffer_load_dwordx2 v[38:39], v4, s[20:23], s55 offen offset:768 sc1
    s_waitcnt lgkmcnt(8)
    v_mfma_f32_32x32x16_bf16 v[224:239], v[24:27], v[64:67], v[224:239]
    ds_read_b64_tr_b16 v[24:25], v5 offset:17408
    ds_read_b64_tr_b16 v[26:27], v5 offset:17920
    v_mfma_f32_32x32x16_bf16 v[240:255], v[28:31], v[64:67], v[240:255]
    ds_read_b64_tr_b16 v[28:29], v5 offset:21504
    ds_read_b64_tr_b16 v[30:31], v5 offset:22016
    buffer_load_dwordx2 v[40:41], v4, s[20:23], s55 offen offset:1024 sc1
    s_waitcnt vmcnt(27) lgkmcnt(8)
    v_mfma_f32_32x32x16_bf16 v[160:175], v[8:11], v[68:71], v[160:175]
    ds_read_b64_tr_b16 v[8:9], v5 offset:2048
    ds_read_b64_tr_b16 v[10:11], v5 offset:2560
    v_mfma_f32_32x32x16_bf16 v[176:191], v[12:15], v[68:71], v[176:191]
    ds_read_b64_tr_b16 v[12:13], v5 offset:6144
    ds_read_b64_tr_b16 v[14:15], v5 offset:6656
    buffer_load_dwordx2 v[42:43], v4, s[20:23], s55 offen offset:1280 sc1
    s_waitcnt lgkmcnt(8)
    v_mfma_f32_32x32x16_bf16 v[192:207], v[16:19], v[68:71], v[192:207]
    ds_read_b64_tr_b16 v[16:17], v5 offset:10240
    ds_read_b64_tr_b16 v[18:19], v5 offset:10752
    v_mfma_f32_32x32x16_bf16 v[208:223], v[20:23], v[68:71], v[208:223]
    ds_read_b64_tr_b16 v[20:21], v5 offset:14336
    ds_read_b64_tr_b16 v[22:23], v5 offset:14848
    buffer_load_dwordx2 v[44:45], v4, s[20:23], s55 offen offset:1536 sc1
    s_waitcnt lgkmcnt(8)
    v_mfma_f32_32x32x16_bf16 v[224:239], v[24:27], v[68:71], v[224:239]
    ds_read_b64_tr_b16 v[24:25], v5 offset:18432
    ds_read_b64_tr_b16 v[26:27], v5 offset:18944
    v_mfma_f32_32x32x16_bf16 v[240:255], v[28:31], v[68:71], v[240:255]
    ds_read_b64_tr_b16 v[28:29], v5 offset:22528
    ds_read_b64_tr_b16 v[30:31], v5 offset:23040
    buffer_load_dwordx2 v[46:47], v4, s[20:23], s55 offen offset:1792 sc1
    s_waitcnt vmcnt(29) lgkmcnt(8)
    v_mfma_f32_32x32x16_bf16 v[160:175], v[8:11], v[72:75], v[160:175]
    ds_read_b64_tr_b16 v[8:9], v5 offset:3072
    ds_read_b64_tr_b16 v[10:11], v5 offset:3584
    v_mfma_f32_32x32x16_bf16 v[176:191], v[12:15], v[72:75], v[176:191]
    ds_read_b64_tr_b16 v[12:13], v5 offset:7168
    ds_read_b64_tr_b16 v[14:15], v5 offset:7680
    s_waitcnt lgkmcnt(8)
    v_mfma_f32_32x32x16_bf16 v[192:207], v[16:19], v[72:75], v[192:207]
    ds_read_b64_tr_b16 v[16:17], v5 offset:11264
    ds_read_b64_tr_b16 v[18:19], v5 offset:11776
    v_mfma_f32_32x32x16_bf16 v[208:223], v[20:23], v[72:75], v[208:223]
    ds_read_b64_tr_b16 v[20:21], v5 offset:15360
    ds_read_b64_tr_b16 v[22:23], v5 offset:15872
    s_waitcnt lgkmcnt(8)
    v_mfma_f32_32x32x16_bf16 v[224:239], v[24:27], v[72:75], v[224:239]
    ds_read_b64_tr_b16 v[24:25], v5 offset:19456
    ds_read_b64_tr_b16 v[26:27], v5 offset:19968
    v_mfma_f32_32x32x16_bf16 v[240:255], v[28:31], v[72:75], v[240:255]
    ds_read_b64_tr_b16 v[28:29], v5 offset:23552
    ds_read_b64_tr_b16 v[30:31], v5 offset:24064
    s_waitcnt lgkmcnt(0)
    s_barrier
    v_add_u32 v5, 0, v7
    s_waitcnt vmcnt(28) lgkmcnt(8)
    v_mfma_f32_32x32x16_bf16 v[160:175], v[8:11], v[76:79], v[160:175]
    ds_read_b64_tr_b16 v[8:9], v5 offset:0
    ds_read_b64_tr_b16 v[10:11], v5 offset:512
    v_mfma_f32_32x32x16_bf16 v[176:191], v[12:15], v[76:79], v[176:191]
    ds_read_b64_tr_b16 v[12:13], v5 offset:4096
    ds_read_b64_tr_b16 v[14:15], v5 offset:4608
    s_waitcnt lgkmcnt(8)
    v_mfma_f32_32x32x16_bf16 v[192:207], v[16:19], v[76:79], v[192:207]
    ds_read_b64_tr_b16 v[16:17], v5 offset:8192
    ds_read_b64_tr_b16 v[18:19], v5 offset:8704
    v_mfma_f32_32x32x16_bf16 v[208:223], v[20:23], v[76:79], v[208:223]
    ds_read_b64_tr_b16 v[20:21], v5 offset:12288
    ds_read_b64_tr_b16 v[22:23], v5 offset:12800
    s_waitcnt lgkmcnt(8)
    v_mfma_f32_32x32x16_bf16 v[224:239], v[24:27], v[76:79], v[224:239]
    ds_read_b64_tr_b16 v[24:25], v5 offset:16384
    ds_read_b64_tr_b16 v[26:27], v5 offset:16896
    v_mfma_f32_32x32x16_bf16 v[240:255], v[28:31], v[76:79], v[240:255]
    ds_read_b64_tr_b16 v[28:29], v5 offset:20480
    ds_read_b64_tr_b16 v[30:31], v5 offset:20992
    s_waitcnt vmcnt(27) lgkmcnt(8)
    v_mfma_f32_32x32x16_bf16 v[160:175], v[8:11], v[80:83], v[160:175]
    ds_read_b64_tr_b16 v[8:9], v5 offset:1024
    ds_read_b64_tr_b16 v[10:11], v5 offset:1536
    v_mfma_f32_32x32x16_bf16 v[176:191], v[12:15], v[80:83], v[176:191]
    ds_read_b64_tr_b16 v[12:13], v5 offset:5120
    ds_read_b64_tr_b16 v[14:15], v5 offset:5632
    s_waitcnt lgkmcnt(8)
    v_mfma_f32_32x32x16_bf16 v[192:207], v[16:19], v[80:83], v[192:207]
    ds_read_b64_tr_b16 v[16:17], v5 offset:9216
    ds_read_b64_tr_b16 v[18:19], v5 offset:9728
    v_mfma_f32_32x32x16_bf16 v[208:223], v[20:23], v[80:83], v[208:223]
    ds_read_b64_tr_b16 v[20:21], v5 offset:13312
    ds_read_b64_tr_b16 v[22:23], v5 offset:13824
    s_waitcnt lgkmcnt(8)
    v_mfma_f32_32x32x16_bf16 v[224:239], v[24:27], v[80:83], v[224:239]
    ds_read_b64_tr_b16 v[24:25], v5 offset:17408
    ds_read_b64_tr_b16 v[26:27], v5 offset:17920
    v_mfma_f32_32x32x16_bf16 v[240:255], v[28:31], v[80:83], v[240:255]
    ds_read_b64_tr_b16 v[28:29], v5 offset:21504
    ds_read_b64_tr_b16 v[30:31], v5 offset:22016
    s_waitcnt vmcnt(26) lgkmcnt(8)
    v_mfma_f32_32x32x16_bf16 v[160:175], v[8:11], v[84:87], v[160:175]
    ds_read_b64_tr_b16 v[8:9], v5 offset:2048
    ds_read_b64_tr_b16 v[10:11], v5 offset:2560
    v_mfma_f32_32x32x16_bf16 v[176:191], v[12:15], v[84:87], v[176:191]
    ds_read_b64_tr_b16 v[12:13], v5 offset:6144
    ds_read_b64_tr_b16 v[14:15], v5 offset:6656
    s_waitcnt lgkmcnt(8)
    v_mfma_f32_32x32x16_bf16 v[192:207], v[16:19], v[84:87], v[192:207]
    ds_read_b64_tr_b16 v[16:17], v5 offset:10240
    ds_read_b64_tr_b16 v[18:19], v5 offset:10752
    v_mfma_f32_32x32x16_bf16 v[208:223], v[20:23], v[84:87], v[208:223]
    ds_read_b64_tr_b16 v[20:21], v5 offset:14336
    ds_read_b64_tr_b16 v[22:23], v5 offset:14848
    s_waitcnt lgkmcnt(8)
    v_mfma_f32_32x32x16_bf16 v[224:239], v[24:27], v[84:87], v[224:239]
    ds_read_b64_tr_b16 v[24:25], v5 offset:18432
    ds_read_b64_tr_b16 v[26:27], v5 offset:18944
    v_mfma_f32_32x32x16_bf16 v[240:255], v[28:31], v[84:87], v[240:255]
    ds_read_b64_tr_b16 v[28:29], v5 offset:22528
    ds_read_b64_tr_b16 v[30:31], v5 offset:23040
    s_waitcnt vmcnt(25) lgkmcnt(8)
    v_mfma_f32_32x32x16_bf16 v[160:175], v[8:11], v[88:91], v[160:175]
    ds_read_b64_tr_b16 v[8:9], v5 offset:3072
    ds_read_b64_tr_b16 v[10:11], v5 offset:3584
    v_mfma_f32_32x32x16_bf16 v[176:191], v[12:15], v[88:91], v[176:191]
    ds_read_b64_tr_b16 v[12:13], v5 offset:7168
    ds_read_b64_tr_b16 v[14:15], v5 offset:7680
    s_waitcnt lgkmcnt(8)
    v_mfma_f32_32x32x16_bf16 v[192:207], v[16:19], v[88:91], v[192:207]
    ds_read_b64_tr_b16 v[16:17], v5 offset:11264
    ds_read_b64_tr_b16 v[18:19], v5 offset:11776
    v_mfma_f32_32x32x16_bf16 v[208:223], v[20:23], v[88:91], v[208:223]
    ds_read_b64_tr_b16 v[20:21], v5 offset:15360
    ds_read_b64_tr_b16 v[22:23], v5 offset:15872
    s_waitcnt lgkmcnt(8)
    v_mfma_f32_32x32x16_bf16 v[224:239], v[24:27], v[88:91], v[224:239]
    ds_read_b64_tr_b16 v[24:25], v5 offset:19456
    ds_read_b64_tr_b16 v[26:27], v5 offset:19968
    v_mfma_f32_32x32x16_bf16 v[240:255], v[28:31], v[88:91], v[240:255]
    ds_read_b64_tr_b16 v[28:29], v5 offset:23552
    ds_read_b64_tr_b16 v[30:31], v5 offset:24064
    v_add_u32 v5, 24576, v7
    s_waitcnt vmcnt(24) lgkmcnt(8)
    v_mfma_f32_32x32x16_bf16 v[160:175], v[8:11], v[92:95], v[160:175]
    ds_read_b64_tr_b16 v[8:9], v5 offset:0
    ds_read_b64_tr_b16 v[10:11], v5 offset:512
    v_mfma_f32_32x32x16_bf16 v[176:191], v[12:15], v[92:95], v[176:191]
    ds_read_b64_tr_b16 v[12:13], v5 offset:4096
    ds_read_b64_tr_b16 v[14:15], v5 offset:4608
    s_waitcnt lgkmcnt(8)
    v_mfma_f32_32x32x16_bf16 v[192:207], v[16:19], v[92:95], v[192:207]
    ds_read_b64_tr_b16 v[16:17], v5 offset:8192
    ds_read_b64_tr_b16 v[18:19], v5 offset:8704
    v_mfma_f32_32x32x16_bf16 v[208:223], v[20:23], v[92:95], v[208:223]
    ds_read_b64_tr_b16 v[20:21], v5 offset:12288
    ds_read_b64_tr_b16 v[22:23], v5 offset:12800
    s_waitcnt lgkmcnt(8)
    v_mfma_f32_32x32x16_bf16 v[224:239], v[24:27], v[92:95], v[224:239]
    ds_read_b64_tr_b16 v[24:25], v5 offset:16384
    ds_read_b64_tr_b16 v[26:27], v5 offset:16896
    v_mfma_f32_32x32x16_bf16 v[240:255], v[28:31], v[92:95], v[240:255]
    ds_read_b64_tr_b16 v[28:29], v5 offset:20480
    ds_read_b64_tr_b16 v[30:31], v5 offset:20992
    s_waitcnt vmcnt(0) lgkmcnt(8)
    v_mfma_f32_32x32x16_bf16 v[160:175], v[8:11], v[96:99], v[160:175]
    ds_read_b64_tr_b16 v[8:9], v5 offset:1024
    ds_read_b64_tr_b16 v[10:11], v5 offset:1536
    v_add_f32 v32, v32, v34
    v_add_f32 v33, v33, v35
    v_mfma_f32_32x32x16_bf16 v[176:191], v[12:15], v[96:99], v[176:191]
    ds_read_b64_tr_b16 v[12:13], v5 offset:5120
    ds_read_b64_tr_b16 v[14:15], v5 offset:5632
    v_add_f32 v32, v32, v36
    v_add_f32 v33, v33, v37
    s_waitcnt lgkmcnt(8)
    v_mfma_f32_32x32x16_bf16 v[192:207], v[16:19], v[96:99], v[192:207]
    ds_read_b64_tr_b16 v[16:17], v5 offset:9216
    ds_read_b64_tr_b16 v[18:19], v5 offset:9728
    v_add_f32 v32, v32, v38
    v_add_f32 v33, v33, v39
    v_mfma_f32_32x32x16_bf16 v[208:223], v[20:23], v[96:99], v[208:223]
    ds_read_b64_tr_b16 v[20:21], v5 offset:13312
    ds_read_b64_tr_b16 v[22:23], v5 offset:13824
    v_add_f32 v32, v32, v40
    v_add_f32 v33, v33, v41
    s_waitcnt lgkmcnt(8)
    v_mfma_f32_32x32x16_bf16 v[224:239], v[24:27], v[96:99], v[224:239]
    ds_read_b64_tr_b16 v[24:25], v5 offset:17408
    ds_read_b64_tr_b16 v[26:27], v5 offset:17920
    v_add_f32 v32, v32, v42
    v_add_f32 v33, v33, v43
    v_mfma_f32_32x32x16_bf16 v[240:255], v[28:31], v[96:99], v[240:255]
    ds_read_b64_tr_b16 v[28:29], v5 offset:21504
    ds_read_b64_tr_b16 v[30:31], v5 offset:22016
    v_add_f32 v32, v32, v44
    v_add_f32 v33, v33, v45
    s_waitcnt lgkmcnt(8)
    v_mfma_f32_32x32x16_bf16 v[160:175], v[8:11], v[100:103], v[160:175]
    ds_read_b64_tr_b16 v[8:9], v5 offset:2048
    ds_read_b64_tr_b16 v[10:11], v5 offset:2560
    v_add_f32 v32, v32, v46
    v_add_f32 v33, v33, v47
    v_mfma_f32_32x32x16_bf16 v[176:191], v[12:15], v[100:103], v[176:191]
    ds_read_b64_tr_b16 v[12:13], v5 offset:6144
    ds_read_b64_tr_b16 v[14:15], v5 offset:6656
    v_mov_b32 v34, v32
    v_mov_b32 v35, v33
    s_waitcnt lgkmcnt(8)
    v_mfma_f32_32x32x16_bf16 v[192:207], v[16:19], v[100:103], v[192:207]
    ds_read_b64_tr_b16 v[16:17], v5 offset:10240
    ds_read_b64_tr_b16 v[18:19], v5 offset:10752
    s_nop 1
    v_permlane32_swap_b32 v32, v34
    v_mfma_f32_32x32x16_bf16 v[208:223], v[20:23], v[100:103], v[208:223]
    ds_read_b64_tr_b16 v[20:21], v5 offset:14336
    ds_read_b64_tr_b16 v[22:23], v5 offset:14848
    v_permlane32_swap_b32 v33, v35
    s_nop 1
    s_waitcnt lgkmcnt(8)
    v_mfma_f32_32x32x16_bf16 v[224:239], v[24:27], v[100:103], v[224:239]
    ds_read_b64_tr_b16 v[24:25], v5 offset:18432
    ds_read_b64_tr_b16 v[26:27], v5 offset:18944
    v_add_f32 v32, v32, v34
    v_add_f32 v33, v33, v35
    v_mfma_f32_32x32x16_bf16 v[240:255], v[28:31], v[100:103], v[240:255]
    ds_read_b64_tr_b16 v[28:29], v5 offset:22528
    ds_read_b64_tr_b16 v[30:31], v5 offset:23040
    v_mul_f32 v4, s56, v32
    v_mul_f32 v3, s56, v33
    s_waitcnt lgkmcnt(8)
    v_mfma_f32_32x32x16_bf16 v[160:175], v[8:11], v[104:107], v[160:175]
    ds_read_b64_tr_b16 v[8:9], v5 offset:3072
    ds_read_b64_tr_b16 v[10:11], v5 offset:3584
    v_fma_f32 v3, -v4, v4, v3
    v_max_f32 v3, 0, v3
    v_mfma_f32_32x32x16_bf16 v[176:191], v[12:15], v[104:107], v[176:191]
    ds_read_b64_tr_b16 v[12:13], v5 offset:7168
    ds_read_b64_tr_b16 v[14:15], v5 offset:7680
    v_cvt_pk_bf16_f32 v36, v4, v3
    v_lshlrev_b32 v4, 16, v36
    s_waitcnt lgkmcnt(8)
    v_mfma_f32_32x32x16_bf16 v[192:207], v[16:19], v[104:107], v[192:207]
    ds_read_b64_tr_b16 v[16:17], v5 offset:11264
    ds_read_b64_tr_b16 v[18:19], v5 offset:11776
    v_and_b32 v3, 0xffff0000, v36
    v_add_f32 v3, s57, v3
    v_mfma_f32_32x32x16_bf16 v[208:223], v[20:23], v[104:107], v[208:223]
    ds_read_b64_tr_b16 v[20:21], v5 offset:15360
    ds_read_b64_tr_b16 v[22:23], v5 offset:15872
    v_cvt_pk_bf16_f32 v36, v3, v3
    v_and_b32 v3, 0xffff0000, v36
    s_waitcnt lgkmcnt(8)
    v_mfma_f32_32x32x16_bf16 v[224:239], v[24:27], v[104:107], v[224:239]
    ds_read_b64_tr_b16 v[24:25], v5 offset:19456
    ds_read_b64_tr_b16 v[26:27], v5 offset:19968
    v_sqrt_f32 v3, v3
    v_sub_f32 v4, 0, v4
    v_mfma_f32_32x32x16_bf16 v[240:255], v[28:31], v[104:107], v[240:255]
    ds_read_b64_tr_b16 v[28:29], v5 offset:23552
    ds_read_b64_tr_b16 v[30:31], v5 offset:24064
    v_cvt_pk_bf16_f32 v36, v3, v3
    v_and_b32 v3, 0xffff0000, v36
    v_add_u32 v5, 49152, v7
    s_waitcnt lgkmcnt(8)
    v_mfma_f32_32x32x16_bf16 v[160:175], v[8:11], v[108:111], v[160:175]
    ds_read_b64_tr_b16 v[8:9], v5 offset:0
    ds_read_b64_tr_b16 v[10:11], v5 offset:512
    v_rcp_f32 v2, v3
    s_nop 0
    v_mfma_f32_32x32x16_bf16 v[176:191], v[12:15], v[108:111], v[176:191]
    ds_read_b64_tr_b16 v[12:13], v5 offset:4096
    ds_read_b64_tr_b16 v[14:15], v5 offset:4608
    v_mul_f32 v2, s58, v2
    s_waitcnt lgkmcnt(8)
    v_mfma_f32_32x32x16_bf16 v[192:207], v[16:19], v[108:111], v[192:207]
    ds_read_b64_tr_b16 v[16:17], v5 offset:8192
    ds_read_b64_tr_b16 v[18:19], v5 offset:8704
    v_mfma_f32_32x32x16_bf16 v[208:223], v[20:23], v[108:111], v[208:223]
    ds_read_b64_tr_b16 v[20:21], v5 offset:12288
    ds_read_b64_tr_b16 v[22:23], v5 offset:12800
    s_waitcnt lgkmcnt(8)
    v_mfma_f32_32x32x16_bf16 v[224:239], v[24:27], v[108:111], v[224:239]
    ds_read_b64_tr_b16 v[24:25], v5 offset:16384
    ds_read_b64_tr_b16 v[26:27], v5 offset:16896
    v_mfma_f32_32x32x16_bf16 v[240:255], v[28:31], v[108:111], v[240:255]
    ds_read_b64_tr_b16 v[28:29], v5 offset:20480
    ds_read_b64_tr_b16 v[30:31], v5 offset:20992
    s_waitcnt lgkmcnt(8)
    v_mfma_f32_32x32x16_bf16 v[160:175], v[8:11], v[112:115], v[160:175]
    ds_read_b64_tr_b16 v[8:9], v5 offset:1024
    ds_read_b64_tr_b16 v[10:11], v5 offset:1536
    v_mfma_f32_32x32x16_bf16 v[176:191], v[12:15], v[112:115], v[176:191]
    ds_read_b64_tr_b16 v[12:13], v5 offset:5120
    ds_read_b64_tr_b16 v[14:15], v5 offset:5632
    s_waitcnt lgkmcnt(8)
    v_mfma_f32_32x32x16_bf16 v[192:207], v[16:19], v[112:115], v[192:207]
    ds_read_b64_tr_b16 v[16:17], v5 offset:9216
    ds_read_b64_tr_b16 v[18:19], v5 offset:9728
    v_mfma_f32_32x32x16_bf16 v[208:223], v[20:23], v[112:115], v[208:223]
    ds_read_b64_tr_b16 v[20:21], v5 offset:13312
    ds_read_b64_tr_b16 v[22:23], v5 offset:13824
    s_waitcnt lgkmcnt(8)
    v_mfma_f32_32x32x16_bf16 v[224:239], v[24:27], v[112:115], v[224:239]
    ds_read_b64_tr_b16 v[24:25], v5 offset:17408
    ds_read_b64_tr_b16 v[26:27], v5 offset:17920
    v_mfma_f32_32x32x16_bf16 v[240:255], v[28:31], v[112:115], v[240:255]
    ds_read_b64_tr_b16 v[28:29], v5 offset:21504
    ds_read_b64_tr_b16 v[30:31], v5 offset:22016
    s_waitcnt lgkmcnt(8)
    v_mfma_f32_32x32x16_bf16 v[160:175], v[8:11], v[116:119], v[160:175]
    ds_read_b64_tr_b16 v[8:9], v5 offset:2048
    ds_read_b64_tr_b16 v[10:11], v5 offset:2560
    v_mfma_f32_32x32x16_bf16 v[176:191], v[12:15], v[116:119], v[176:191]
    ds_read_b64_tr_b16 v[12:13], v5 offset:6144
    ds_read_b64_tr_b16 v[14:15], v5 offset:6656
    s_waitcnt lgkmcnt(8)
    v_mfma_f32_32x32x16_bf16 v[192:207], v[16:19], v[116:119], v[192:207]
    ds_read_b64_tr_b16 v[16:17], v5 offset:10240
    ds_read_b64_tr_b16 v[18:19], v5 offset:10752
    v_mfma_f32_32x32x16_bf16 v[208:223], v[20:23], v[116:119], v[208:223]
    ds_read_b64_tr_b16 v[20:21], v5 offset:14336
    ds_read_b64_tr_b16 v[22:23], v5 offset:14848
    s_waitcnt lgkmcnt(8)
    v_mfma_f32_32x32x16_bf16 v[224:239], v[24:27], v[116:119], v[224:239]
    ds_read_b64_tr_b16 v[24:25], v5 offset:18432
    ds_read_b64_tr_b16 v[26:27], v5 offset:18944
    v_mfma_f32_32x32x16_bf16 v[240:255], v[28:31], v[116:119], v[240:255]
    ds_read_b64_tr_b16 v[28:29], v5 offset:22528
    ds_read_b64_tr_b16 v[30:31], v5 offset:23040
    s_waitcnt lgkmcnt(8)
    v_mfma_f32_32x32x16_bf16 v[160:175], v[8:11], v[120:123], v[160:175]
    ds_read_b64_tr_b16 v[8:9], v5 offset:3072
    ds_read_b64_tr_b16 v[10:11], v5 offset:3584
    v_mfma_f32_32x32x16_bf16 v[176:191], v[12:15], v[120:123], v[176:191]
    ds_read_b64_tr_b16 v[12:13], v5 offset:7168
    ds_read_b64_tr_b16 v[14:15], v5 offset:7680
    s_waitcnt lgkmcnt(8)
    v_mfma_f32_32x32x16_bf16 v[192:207], v[16:19], v[120:123], v[192:207]
    ds_read_b64_tr_b16 v[16:17], v5 offset:11264
    ds_read_b64_tr_b16 v[18:19], v5 offset:11776
    v_mfma_f32_32x32x16_bf16 v[208:223], v[20:23], v[120:123], v[208:223]
    ds_read_b64_tr_b16 v[20:21], v5 offset:15360
    ds_read_b64_tr_b16 v[22:23], v5 offset:15872
    s_waitcnt lgkmcnt(8)
    v_mfma_f32_32x32x16_bf16 v[224:239], v[24:27], v[120:123], v[224:239]
    ds_read_b64_tr_b16 v[24:25], v5 offset:19456
    ds_read_b64_tr_b16 v[26:27], v5 offset:19968
    v_mfma_f32_32x32x16_bf16 v[240:255], v[28:31], v[120:123], v[240:255]
    ds_read_b64_tr_b16 v[28:29], v5 offset:23552
    ds_read_b64_tr_b16 v[30:31], v5 offset:24064
    s_waitcnt lgkmcnt(0)
    s_barrier
    v_add_u32 v5, 73728, v7
    v_lshrrev_b32 v7, 5, v6
    v_lshlrev_b32 v7, 4, v7
    v_add_u32 v7, 159744, v7
    s_waitcnt lgkmcnt(8)
    v_mfma_f32_32x32x16_bf16 v[160:175], v[8:11], v[124:127], v[160:175]
    ds_read_b64_tr_b16 v[8:9], v5 offset:0
    ds_read_b64_tr_b16 v[10:11], v5 offset:512
    v_mfma_f32_32x32x16_bf16 v[176:191], v[12:15], v[124:127], v[176:191]
    ds_read_b64_tr_b16 v[12:13], v5 offset:4096
    ds_read_b64_tr_b16 v[14:15], v5 offset:4608
    s_waitcnt lgkmcnt(8)
    v_mfma_f32_32x32x16_bf16 v[192:207], v[16:19], v[124:127], v[192:207]
    ds_read_b64_tr_b16 v[16:17], v5 offset:8192
    ds_read_b64_tr_b16 v[18:19], v5 offset:8704
    v_mfma_f32_32x32x16_bf16 v[208:223], v[20:23], v[124:127], v[208:223]
    ds_read_b64_tr_b16 v[20:21], v5 offset:12288
    ds_read_b64_tr_b16 v[22:23], v5 offset:12800
    s_waitcnt lgkmcnt(8)
    v_mfma_f32_32x32x16_bf16 v[224:239], v[24:27], v[124:127], v[224:239]
    ds_read_b64_tr_b16 v[24:25], v5 offset:16384
    ds_read_b64_tr_b16 v[26:27], v5 offset:16896
    v_mfma_f32_32x32x16_bf16 v[240:255], v[28:31], v[124:127], v[240:255]
    ds_read_b64_tr_b16 v[28:29], v5 offset:20480
    ds_read_b64_tr_b16 v[30:31], v5 offset:20992
    s_waitcnt lgkmcnt(8)
    v_mfma_f32_32x32x16_bf16 v[160:175], v[8:11], v[128:131], v[160:175]
    ds_read_b64_tr_b16 v[8:9], v5 offset:1024
    ds_read_b64_tr_b16 v[10:11], v5 offset:1536
    ds_read_b128 v[32:35], v7 offset:0
    v_mfma_f32_32x32x16_bf16 v[176:191], v[12:15], v[128:131], v[176:191]
    ds_read_b64_tr_b16 v[12:13], v5 offset:5120
    ds_read_b64_tr_b16 v[14:15], v5 offset:5632
    ds_read_b128 v[36:39], v7 offset:32
    s_waitcnt lgkmcnt(10)
    v_mfma_f32_32x32x16_bf16 v[192:207], v[16:19], v[128:131], v[192:207]
    ds_read_b64_tr_b16 v[16:17], v5 offset:9216
    ds_read_b64_tr_b16 v[18:19], v5 offset:9728
    ds_read_b128 v[40:43], v7 offset:64
    v_mfma_f32_32x32x16_bf16 v[208:223], v[20:23], v[128:131], v[208:223]
    ds_read_b64_tr_b16 v[20:21], v5 offset:13312
    ds_read_b64_tr_b16 v[22:23], v5 offset:13824
    ds_read_b128 v[44:47], v7 offset:96
    s_waitcnt lgkmcnt(12)
    v_mfma_f32_32x32x16_bf16 v[224:239], v[24:27], v[128:131], v[224:239]
    ds_read_b64_tr_b16 v[24:25], v5 offset:17408
    ds_read_b64_tr_b16 v[26:27], v5 offset:17920
    ds_read_b128 v[48:51], v7 offset:384
    v_mfma_f32_32x32x16_bf16 v[240:255], v[28:31], v[128:131], v[240:255]
    ds_read_b64_tr_b16 v[28:29], v5 offset:21504
    ds_read_b64_tr_b16 v[30:31], v5 offset:22016
    ds_read_b128 v[52:55], v7 offset:416
    s_waitcnt lgkmcnt(13)
    v_mfma_f32_32x32x16_bf16 v[160:175], v[8:11], v[132:135], v[160:175]
    ds_read_b64_tr_b16 v[8:9], v5 offset:2048
    ds_read_b64_tr_b16 v[10:11], v5 offset:2560
    ds_read_b128 v[56:59], v7 offset:448
    v_mfma_f32_32x32x16_bf16 v[176:191], v[12:15], v[132:135], v[176:191]
    ds_read_b64_tr_b16 v[12:13], v5 offset:6144
    ds_read_b64_tr_b16 v[14:15], v5 offset:6656
    ds_read_b128 v[60:63], v7 offset:480
    s_waitcnt lgkmcnt(13)
    v_mfma_f32_32x32x16_bf16 v[192:207], v[16:19], v[132:135], v[192:207]
    ds_read_b64_tr_b16 v[16:17], v5 offset:10240
    ds_read_b64_tr_b16 v[18:19], v5 offset:10752
    ds_read_b128 v[64:67], v7 offset:128
    v_mfma_f32_32x32x16_bf16 v[208:223], v[20:23], v[132:135], v[208:223]
    ds_read_b64_tr_b16 v[20:21], v5 offset:14336
    ds_read_b64_tr_b16 v[22:23], v5 offset:14848
    ds_read_b128 v[68:71], v7 offset:160
    s_waitcnt lgkmcnt(13)
    v_mfma_f32_32x32x16_bf16 v[224:239], v[24:27], v[132:135], v[224:239]
    ds_read_b64_tr_b16 v[24:25], v5 offset:18432
    ds_read_b64_tr_b16 v[26:27], v5 offset:18944
    ds_read_b128 v[72:75], v7 offset:192
    v_mfma_f32_32x32x16_bf16 v[240:255], v[28:31], v[132:135], v[240:255]
    ds_read_b64_tr_b16 v[28:29], v5 offset:22528
    ds_read_b64_tr_b16 v[30:31], v5 offset:23040
    ds_read_b128 v[76:79], v7 offset:224
    s_waitcnt lgkmcnt(13)
    v_mfma_f32_32x32x16_bf16 v[160:175], v[8:11], v[136:139], v[160:175]
    ds_read_b64_tr_b16 v[8:9], v5 offset:3072
    ds_read_b64_tr_b16 v[10:11], v5 offset:3584
    ds_read_b128 v[80:83], v7 offset:512
    v_mfma_f32_32x32x16_bf16 v[176:191], v[12:15], v[136:139], v[176:191]
    ds_read_b64_tr_b16 v[12:13], v5 offset:7168
    ds_read_b64_tr_b16 v[14:15], v5 offset:7680
    ds_read_b128 v[84:87], v7 offset:544
    s_waitcnt lgkmcnt(13)
    v_mfma_f32_32x32x16_bf16 v[192:207], v[16:19], v[136:139], v[192:207]
    ds_read_b64_tr_b16 v[16:17], v5 offset:11264
    ds_read_b64_tr_b16 v[18:19], v5 offset:11776
    ds_read_b128 v[88:91], v7 offset:576
    v_mfma_f32_32x32x16_bf16 v[208:223], v[20:23], v[136:139], v[208:223]
    ds_read_b64_tr_b16 v[20:21], v5 offset:15360
    ds_read_b64_tr_b16 v[22:23], v5 offset:15872
    ds_read_b128 v[92:95], v7 offset:608
    s_waitcnt lgkmcnt(13)
    v_mfma_f32_32x32x16_bf16 v[224:239], v[24:27], v[136:139], v[224:239]
    ds_read_b64_tr_b16 v[24:25], v5 offset:19456
    ds_read_b64_tr_b16 v[26:27], v5 offset:19968
    ds_read_b128 v[96:99], v7 offset:256
    v_mfma_f32_32x32x16_bf16 v[240:255], v[28:31], v[136:139], v[240:255]
    ds_read_b64_tr_b16 v[28:29], v5 offset:23552
    ds_read_b64_tr_b16 v[30:31], v5 offset:24064
    ds_read_b128 v[100:103], v7 offset:288
    s_waitcnt lgkmcnt(13)
    v_mfma_f32_32x32x16_bf16 v[160:175], v[8:11], v[140:143], v[160:175]
    ds_read_b64_tr_b16 v[8:9], v5 offset:24576
    ds_read_b64_tr_b16 v[10:11], v5 offset:25088
    ds_read_b128 v[104:107], v7 offset:320
    v_mfma_f32_32x32x16_bf16 v[176:191], v[12:15], v[140:143], v[176:191]
    ds_read_b64_tr_b16 v[12:13], v5 offset:28672
    ds_read_b64_tr_b16 v[14:15], v5 offset:29184
    ds_read_b128 v[108:111], v7 offset:352
    s_waitcnt lgkmcnt(13)
    v_mfma_f32_32x32x16_bf16 v[192:207], v[16:19], v[140:143], v[192:207]
    ds_read_b64_tr_b16 v[16:17], v5 offset:32768
    ds_read_b64_tr_b16 v[18:19], v5 offset:33280
    ds_read_b128 v[112:115], v7 offset:640
    v_mfma_f32_32x32x16_bf16 v[208:223], v[20:23], v[140:143], v[208:223]
    ds_read_b64_tr_b16 v[20:21], v5 offset:36864
    ds_read_b64_tr_b16 v[22:23], v5 offset:37376
    ds_read_b128 v[116:119], v7 offset:672
    s_waitcnt lgkmcnt(13)
    v_mfma_f32_32x32x16_bf16 v[224:239], v[24:27], v[140:143], v[224:239]
    ds_read_b64_tr_b16 v[24:25], v5 offset:40960
    ds_read_b64_tr_b16 v[26:27], v5 offset:41472
    ds_read_b128 v[120:123], v7 offset:704
    v_mfma_f32_32x32x16_bf16 v[240:255], v[28:31], v[140:143], v[240:255]
    ds_read_b64_tr_b16 v[28:29], v5 offset:45056
    ds_read_b64_tr_b16 v[30:31], v5 offset:45568
    ds_read_b128 v[124:127], v7 offset:736
    s_waitcnt lgkmcnt(13)
    v_mfma_f32_32x32x16_bf16 v[160:175], v[8:11], v[144:147], v[160:175]
    ds_read_b64_tr_b16 v[8:9], v5 offset:25600
    ds_read_b64_tr_b16 v[10:11], v5 offset:26112
    v_mfma_f32_32x32x16_bf16 v[176:191], v[12:15], v[144:147], v[176:191]
    ds_read_b64_tr_b16 v[12:13], v5 offset:29696
    ds_read_b64_tr_b16 v[14:15], v5 offset:30208
    s_waitcnt lgkmcnt(11)
    v_mfma_f32_32x32x16_bf16 v[192:207], v[16:19], v[144:147], v[192:207]
    ds_read_b64_tr_b16 v[16:17], v5 offset:33792
    ds_read_b64_tr_b16 v[18:19], v5 offset:34304
    v_mfma_f32_32x32x16_bf16 v[208:223], v[20:23], v[144:147], v[208:223]
    ds_read_b64_tr_b16 v[20:21], v5 offset:37888
    ds_read_b64_tr_b16 v[22:23], v5 offset:38400
    s_waitcnt lgkmcnt(9)
    v_mfma_f32_32x32x16_bf16 v[224:239], v[24:27], v[144:147], v[224:239]
    ds_read_b64_tr_b16 v[24:25], v5 offset:41984
    ds_read_b64_tr_b16 v[26:27], v5 offset:42496
    v_mfma_f32_32x32x16_bf16 v[240:255], v[28:31], v[144:147], v[240:255]
    ds_read_b64_tr_b16 v[28:29], v5 offset:46080
    ds_read_b64_tr_b16 v[30:31], v5 offset:46592
    s_waitcnt lgkmcnt(8)
    v_mfma_f32_32x32x16_bf16 v[160:175], v[8:11], v[148:151], v[160:175]
    ds_read_b64_tr_b16 v[8:9], v5 offset:26624
    ds_read_b64_tr_b16 v[10:11], v5 offset:27136
    v_mfma_f32_32x32x16_bf16 v[176:191], v[12:15], v[148:151], v[176:191]
    ds_read_b64_tr_b16 v[12:13], v5 offset:30720
    ds_read_b64_tr_b16 v[14:15], v5 offset:31232
    s_waitcnt lgkmcnt(8)
    v_mfma_f32_32x32x16_bf16 v[192:207], v[16:19], v[148:151], v[192:207]
    ds_read_b64_tr_b16 v[16:17], v5 offset:34816
    ds_read_b64_tr_b16 v[18:19], v5 offset:35328
    v_mfma_f32_32x32x16_bf16 v[208:223], v[20:23], v[148:151], v[208:223]
    ds_read_b64_tr_b16 v[20:21], v5 offset:38912
    ds_read_b64_tr_b16 v[22:23], v5 offset:39424
    s_waitcnt lgkmcnt(8)
    v_mfma_f32_32x32x16_bf16 v[224:239], v[24:27], v[148:151], v[224:239]
    ds_read_b64_tr_b16 v[24:25], v5 offset:43008
    ds_read_b64_tr_b16 v[26:27], v5 offset:43520
    v_mfma_f32_32x32x16_bf16 v[240:255], v[28:31], v[148:151], v[240:255]
    ds_read_b64_tr_b16 v[28:29], v5 offset:47104
    ds_read_b64_tr_b16 v[30:31], v5 offset:47616
    s_waitcnt lgkmcnt(8)
    v_mfma_f32_32x32x16_bf16 v[160:175], v[8:11], v[152:155], v[160:175]
    ds_read_b64_tr_b16 v[8:9], v5 offset:27648
    ds_read_b64_tr_b16 v[10:11], v5 offset:28160
    v_mfma_f32_32x32x16_bf16 v[176:191], v[12:15], v[152:155], v[176:191]
    ds_read_b64_tr_b16 v[12:13], v5 offset:39936
    ds_read_b64_tr_b16 v[14:15], v5 offset:40448
    s_waitcnt lgkmcnt(8)
    v_mfma_f32_32x32x16_bf16 v[192:207], v[16:19], v[152:155], v[192:207]
    ds_read_b64_tr_b16 v[16:17], v5 offset:31744
    ds_read_b64_tr_b16 v[18:19], v5 offset:32256
    v_mfma_f32_32x32x16_bf16 v[208:223], v[20:23], v[152:155], v[208:223]
    ds_read_b64_tr_b16 v[20:21], v5 offset:44032
    ds_read_b64_tr_b16 v[22:23], v5 offset:44544
    s_waitcnt lgkmcnt(8)
    v_mfma_f32_32x32x16_bf16 v[224:239], v[24:27], v[152:155], v[224:239]
    ds_read_b64_tr_b16 v[24:25], v5 offset:35840
    ds_read_b64_tr_b16 v[26:27], v5 offset:36352
    v_mfma_f32_32x32x16_bf16 v[240:255], v[28:31], v[152:155], v[240:255]
    ds_read_b64_tr_b16 v[28:29], v5 offset:48128
    ds_read_b64_tr_b16 v[30:31], v5 offset:48640
    s_waitcnt lgkmcnt(8)
    v_mfma_f32_32x32x16_bf16 v[160:175], v[8:11], v[156:159], v[160:175]
    s_waitcnt lgkmcnt(0)
    s_barrier
    v_mfma_f32_32x32x16_bf16 v[208:223], v[12:15], v[156:159], v[208:223]
    s_waitcnt lgkmcnt(4)
    v_mfma_f32_32x32x16_bf16 v[176:191], v[16:19], v[156:159], v[176:191]
    v_mfma_f32_32x32x16_bf16 v[224:239], v[20:23], v[156:159], v[224:239]
    s_waitcnt lgkmcnt(0)
    v_mfma_f32_32x32x16_bf16 v[192:207], v[24:27], v[156:159], v[192:207]
    v_mfma_f32_32x32x16_bf16 v[240:255], v[28:31], v[156:159], v[240:255]
    s_add_u32 s51, s50, 4096
    s_nop 4
    v_pk_fma_f32 v[160:161], v[32:33], v[4:5], v[160:161] op_sel_hi:[1,0,1]
    v_pk_fma_f32 v[162:163], v[34:35], v[4:5], v[162:163] op_sel_hi:[1,0,1]
    v_pk_fma_f32 v[164:165], v[36:37], v[4:5], v[164:165] op_sel_hi:[1,0,1]
    v_pk_fma_f32 v[166:167], v[38:39], v[4:5], v[166:167] op_sel_hi:[1,0,1]
    v_pk_fma_f32 v[168:169], v[40:41], v[4:5], v[168:169] op_sel_hi:[1,0,1]
    v_pk_fma_f32 v[170:171], v[42:43], v[4:5], v[170:171] op_sel_hi:[1,0,1]
    v_pk_fma_f32 v[172:173], v[44:45], v[4:5], v[172:173] op_sel_hi:[1,0,1]
    v_pk_fma_f32 v[174:175], v[46:47], v[4:5], v[174:175] op_sel_hi:[1,0,1]
    v_pk_mul_f32 v[160:161], v[160:161], v[2:3] op_sel_hi:[1,0]
    v_pk_mul_f32 v[162:163], v[162:163], v[2:3] op_sel_hi:[1,0]
    v_pk_mul_f32 v[164:165], v[164:165], v[2:3] op_sel_hi:[1,0]
    v_pk_mul_f32 v[166:167], v[166:167], v[2:3] op_sel_hi:[1,0]
    v_pk_mul_f32 v[168:169], v[168:169], v[2:3] op_sel_hi:[1,0]
    v_pk_mul_f32 v[170:171], v[170:171], v[2:3] op_sel_hi:[1,0]
    v_pk_mul_f32 v[172:173], v[172:173], v[2:3] op_sel_hi:[1,0]
    v_pk_mul_f32 v[174:175], v[174:175], v[2:3] op_sel_hi:[1,0]
    v_exp_f32 v160, v160
    v_exp_f32 v161, v161
    v_exp_f32 v162, v162
    v_exp_f32 v163, v163
    v_exp_f32 v164, v164
    v_exp_f32 v165, v165
    v_exp_f32 v166, v166
    v_exp_f32 v167, v167
    v_exp_f32 v168, v168
    v_exp_f32 v169, v169
    v_exp_f32 v170, v170
    v_exp_f32 v171, v171
    v_exp_f32 v172, v172
    v_exp_f32 v173, v173
    v_exp_f32 v174, v174
    v_exp_f32 v175, v175
    v_pk_fma_f32 v[208:209], v[48:49], v[4:5], v[208:209] op_sel_hi:[1,0,1]
    v_pk_fma_f32 v[210:211], v[50:51], v[4:5], v[210:211] op_sel_hi:[1,0,1]
    v_pk_fma_f32 v[212:213], v[52:53], v[4:5], v[212:213] op_sel_hi:[1,0,1]
    v_pk_fma_f32 v[214:215], v[54:55], v[4:5], v[214:215] op_sel_hi:[1,0,1]
    v_pk_fma_f32 v[216:217], v[56:57], v[4:5], v[216:217] op_sel_hi:[1,0,1]
    v_pk_fma_f32 v[218:219], v[58:59], v[4:5], v[218:219] op_sel_hi:[1,0,1]
    v_pk_fma_f32 v[220:221], v[60:61], v[4:5], v[220:221] op_sel_hi:[1,0,1]
    v_pk_fma_f32 v[222:223], v[62:63], v[4:5], v[222:223] op_sel_hi:[1,0,1]
    v_pk_fma_f32 v[160:161], v[160:161], v[2:3], v[2:3] op_sel:[0,1,1]
    v_pk_fma_f32 v[162:163], v[162:163], v[2:3], v[2:3] op_sel:[0,1,1]
    v_pk_fma_f32 v[164:165], v[164:165], v[2:3], v[2:3] op_sel:[0,1,1]
    v_pk_fma_f32 v[166:167], v[166:167], v[2:3], v[2:3] op_sel:[0,1,1]
    v_pk_fma_f32 v[168:169], v[168:169], v[2:3], v[2:3] op_sel:[0,1,1]
    v_pk_fma_f32 v[170:171], v[170:171], v[2:3], v[2:3] op_sel:[0,1,1]
    v_pk_fma_f32 v[172:173], v[172:173], v[2:3], v[2:3] op_sel:[0,1,1]
    v_pk_fma_f32 v[174:175], v[174:175], v[2:3], v[2:3] op_sel:[0,1,1]
    v_rcp_f32 v160, v160
    v_rcp_f32 v161, v161
    v_rcp_f32 v162, v162
    v_rcp_f32 v163, v163
    v_rcp_f32 v164, v164
    v_rcp_f32 v165, v165
    v_rcp_f32 v166, v166
    v_rcp_f32 v167, v167
    v_rcp_f32 v168, v168
    v_rcp_f32 v169, v169
    v_rcp_f32 v170, v170
    v_rcp_f32 v171, v171
    v_rcp_f32 v172, v172
    v_rcp_f32 v173, v173
    v_rcp_f32 v174, v174
    v_rcp_f32 v175, v175
    s_nop 0
    v_pk_mul_f32 v[160:161], v[160:161], v[208:209]
    v_pk_mul_f32 v[162:163], v[162:163], v[210:211]
    v_pk_mul_f32 v[164:165], v[164:165], v[212:213]
    v_pk_mul_f32 v[166:167], v[166:167], v[214:215]
    v_pk_mul_f32 v[168:169], v[168:169], v[216:217]
    v_pk_mul_f32 v[170:171], v[170:171], v[218:219]
    v_pk_mul_f32 v[172:173], v[172:173], v[220:221]
    v_pk_mul_f32 v[174:175], v[174:175], v[222:223]
    v_cvt_pk_bf16_f32 v208, v160, v161
    v_cvt_pk_bf16_f32 v209, v162, v163
    v_cvt_pk_bf16_f32 v210, v164, v165
    v_cvt_pk_bf16_f32 v211, v166, v167
    v_cvt_pk_bf16_f32 v212, v168, v169
    v_cvt_pk_bf16_f32 v213, v170, v171
    v_cvt_pk_bf16_f32 v214, v172, v173
    v_cvt_pk_bf16_f32 v215, v174, v175
    s_cmp_lg_u32 s36, 0
    s_cbranch_scc1 tail_sg0_d
    buffer_store_dwordx4 v[208:211], v1, s[20:23], s50 offen offset:0
    buffer_store_dwordx4 v[212:215], v1, s[20:23], s50 offen offset:1024
    s_branch tail_sg0_e
tail_sg0_d:
    buffer_store_dwordx4 v[208:211], v1, s[20:23], s50 offen offset:0 sc0 sc1
    buffer_store_dwordx4 v[212:215], v1, s[20:23], s50 offen offset:1024 sc0 sc1
tail_sg0_e:
    v_pk_fma_f32 v[176:177], v[64:65], v[4:5], v[176:177] op_sel_hi:[1,0,1]
    v_pk_fma_f32 v[178:179], v[66:67], v[4:5], v[178:179] op_sel_hi:[1,0,1]
    v_pk_fma_f32 v[180:181], v[68:69], v[4:5], v[180:181] op_sel_hi:[1,0,1]
    v_pk_fma_f32 v[182:183], v[70:71], v[4:5], v[182:183] op_sel_hi:[1,0,1]
    v_pk_fma_f32 v[184:185], v[72:73], v[4:5], v[184:185] op_sel_hi:[1,0,1]
    v_pk_fma_f32 v[186:187], v[74:75], v[4:5], v[186:187] op_sel_hi:[1,0,1]
    v_pk_fma_f32 v[188:189], v[76:77], v[4:5], v[188:189] op_sel_hi:[1,0,1]
    v_pk_fma_f32 v[190:191], v[78:79], v[4:5], v[190:191] op_sel_hi:[1,0,1]
    v_pk_mul_f32 v[176:177], v[176:177], v[2:3] op_sel_hi:[1,0]
    v_pk_mul_f32 v[178:179], v[178:179], v[2:3] op_sel_hi:[1,0]
    v_pk_mul_f32 v[180:181], v[180:181], v[2:3] op_sel_hi:[1,0]
    v_pk_mul_f32 v[182:183], v[182:183], v[2:3] op_sel_hi:[1,0]
    v_pk_mul_f32 v[184:185], v[184:185], v[2:3] op_sel_hi:[1,0]
    v_pk_mul_f32 v[186:187], v[186:187], v[2:3] op_sel_hi:[1,0]
    v_pk_mul_f32 v[188:189], v[188:189], v[2:3] op_sel_hi:[1,0]
    v_pk_mul_f32 v[190:191], v[190:191], v[2:3] op_sel_hi:[1,0]
    v_exp_f32 v176, v176
    v_exp_f32 v177, v177
    v_exp_f32 v178, v178
    v_exp_f32 v179, v179
    v_exp_f32 v180, v180
    v_exp_f32 v181, v181
    v_exp_f32 v182, v182
    v_exp_f32 v183, v183
    v_exp_f32 v184, v184
    v_exp_f32 v185, v185
    v_exp_f32 v186, v186
    v_exp_f32 v187, v187
    v_exp_f32 v188, v188
    v_exp_f32 v189, v189
    v_exp_f32 v190, v190
    v_exp_f32 v191, v191
    v_pk_fma_f32 v[224:225], v[80:81], v[4:5], v[224:225] op_sel_hi:[1,0,1]
    v_pk_fma_f32 v[226:227], v[82:83], v[4:5], v[226:227] op_sel_hi:[1,0,1]
    v_pk_fma_f32 v[228:229], v[84:85], v[4:5], v[228:229] op_sel_hi:[1,0,1]
    v_pk_fma_f32 v[230:231], v[86:87], v[4:5], v[230:231] op_sel_hi:[1,0,1]
    v_pk_fma_f32 v[232:233], v[88:89], v[4:5], v[232:233] op_sel_hi:[1,0,1]
    v_pk_fma_f32 v[234:235], v[90:91], v[4:5], v[234:235] op_sel_hi:[1,0,1]
    v_pk_fma_f32 v[236:237], v[92:93], v[4:5], v[236:237] op_sel_hi:[1,0,1]
    v_pk_fma_f32 v[238:239], v[94:95], v[4:5], v[238:239] op_sel_hi:[1,0,1]
    v_pk_fma_f32 v[176:177], v[176:177], v[2:3], v[2:3] op_sel:[0,1,1]
    v_pk_fma_f32 v[178:179], v[178:179], v[2:3], v[2:3] op_sel:[0,1,1]
    v_pk_fma_f32 v[180:181], v[180:181], v[2:3], v[2:3] op_sel:[0,1,1]
    v_pk_fma_f32 v[182:183], v[182:183], v[2:3], v[2:3] op_sel:[0,1,1]
    v_pk_fma_f32 v[184:185], v[184:185], v[2:3], v[2:3] op_sel:[0,1,1]
    v_pk_fma_f32 v[186:187], v[186:187], v[2:3], v[2:3] op_sel:[0,1,1]
    v_pk_fma_f32 v[188:189], v[188:189], v[2:3], v[2:3] op_sel:[0,1,1]
    v_pk_fma_f32 v[190:191], v[190:191], v[2:3], v[2:3] op_sel:[0,1,1]
    v_rcp_f32 v176, v176
    v_rcp_f32 v177, v177
    v_rcp_f32 v178, v178
    v_rcp_f32 v179, v179
    v_rcp_f32 v180, v180
    v_rcp_f32 v181, v181
    v_rcp_f32 v182, v182
    v_rcp_f32 v183, v183
    v_rcp_f32 v184, v184
    v_rcp_f32 v185, v185
    v_rcp_f32 v186, v186
    v_rcp_f32 v187, v187
    v_rcp_f32 v188, v188
    v_rcp_f32 v189, v189
    v_rcp_f32 v190, v190
    v_rcp_f32 v191, v191
    s_nop 0
    v_pk_mul_f32 v[176:177], v[176:177], v[224:225]
    v_pk_mul_f32 v[178:179], v[178:179], v[226:227]
    v_pk_mul_f32 v[180:181], v[180:181], v[228:229]
    v_pk_mul_f32 v[182:183], v[182:183], v[230:231]
    v_pk_mul_f32 v[184:185], v[184:185], v[232:233]
    v_pk_mul_f32 v[186:187], v[186:187], v[234:235]
    v_pk_mul_f32 v[188:189], v[188:189], v[236:237]
    v_pk_mul_f32 v[190:191], v[190:191], v[238:239]
    v_cvt_pk_bf16_f32 v224, v176, v177
    v_cvt_pk_bf16_f32 v225, v178, v179
    v_cvt_pk_bf16_f32 v226, v180, v181
    v_cvt_pk_bf16_f32 v227, v182, v183
    v_cvt_pk_bf16_f32 v228, v184, v185
    v_cvt_pk_bf16_f32 v229, v186, v187
    v_cvt_pk_bf16_f32 v230, v188, v189
    v_cvt_pk_bf16_f32 v231, v190, v191
    s_cmp_eq_u32 s43, 14
    s_cselect_b32 s51, 0x40000000, s51
    s_cbranch_scc0 tail_c4s
    v_mov_b32 v224, 0
    v_mov_b32 v225, 0
    v_mov_b32 v226, 0
    v_mov_b32 v227, 0
    v_mov_b32 v228, 0
    v_mov_b32 v229, 0
    v_mov_b32 v230, 0
    v_mov_b32 v231, 0
tail_c4s:
    s_cmp_lg_u32 s36, 0
    s_cbranch_scc1 tail_sg1_d
    buffer_store_dwordx4 v[224:227], v1, s[20:23], s50 offen offset:2048
    buffer_store_dwordx4 v[228:231], v1, s[20:23], s50 offen offset:3072
    s_branch tail_sg1_e
tail_sg1_d:
    buffer_store_dwordx4 v[224:227], v1, s[20:23], s50 offen offset:2048 sc0 sc1
    buffer_store_dwordx4 v[228:231], v1, s[20:23], s50 offen offset:3072 sc0 sc1
tail_sg1_e:
    s_nop 3
    v_pk_fma_f32 v[192:193], v[96:97], v[4:5], v[192:193] op_sel_hi:[1,0,1]
    v_pk_fma_f32 v[194:195], v[98:99], v[4:5], v[194:195] op_sel_hi:[1,0,1]
    v_pk_fma_f32 v[196:197], v[100:101], v[4:5], v[196:197] op_sel_hi:[1,0,1]
    v_pk_fma_f32 v[198:199], v[102:103], v[4:5], v[198:199] op_sel_hi:[1,0,1]
    v_pk_fma_f32 v[200:201], v[104:105], v[4:5], v[200:201] op_sel_hi:[1,0,1]
    v_pk_fma_f32 v[202:203], v[106:107], v[4:5], v[202:203] op_sel_hi:[1,0,1]
    v_pk_fma_f32 v[204:205], v[108:109], v[4:5], v[204:205] op_sel_hi:[1,0,1]
    v_pk_fma_f32 v[206:207], v[110:111], v[4:5], v[206:207] op_sel_hi:[1,0,1]
    v_pk_mul_f32 v[192:193], v[192:193], v[2:3] op_sel_hi:[1,0]
    v_pk_mul_f32 v[194:195], v[194:195], v[2:3] op_sel_hi:[1,0]
    v_pk_mul_f32 v[196:197], v[196:197], v[2:3] op_sel_hi:[1,0]
    v_pk_mul_f32 v[198:199], v[198:199], v[2:3] op_sel_hi:[1,0]
    v_pk_mul_f32 v[200:201], v[200:201], v[2:3] op_sel_hi:[1,0]
    v_pk_mul_f32 v[202:203], v[202:203], v[2:3] op_sel_hi:[1,0]
    v_pk_mul_f32 v[204:205], v[204:205], v[2:3] op_sel_hi:[1,0]
    v_pk_mul_f32 v[206:207], v[206:207], v[2:3] op_sel_hi:[1,0]
    v_exp_f32 v192, v192
    v_exp_f32 v193, v193
    v_exp_f32 v194, v194
    v_exp_f32 v195, v195
    v_exp_f32 v196, v196
    v_exp_f32 v197, v197
    v_exp_f32 v198, v198
    v_exp_f32 v199, v199
    v_exp_f32 v200, v200
    v_exp_f32 v201, v201
    v_exp_f32 v202, v202
    v_exp_f32 v203, v203
    v_exp_f32 v204, v204
    v_exp_f32 v205, v205
    v_exp_f32 v206, v206
    v_exp_f32 v207, v207
    v_pk_fma_f32 v[240:241], v[112:113], v[4:5], v[240:241] op_sel_hi:[1,0,1]
    v_pk_fma_f32 v[242:243], v[114:115], v[4:5], v[242:243] op_sel_hi:[1,0,1]
    v_pk_fma_f32 v[244:245], v[116:117], v[4:5], v[244:245] op_sel_hi:[1,0,1]
    v_pk_fma_f32 v[246:247], v[118:119], v[4:5], v[246:247] op_sel_hi:[1,0,1]
    v_pk_fma_f32 v[248:249], v[120:121], v[4:5], v[248:249] op_sel_hi:[1,0,1]
    v_pk_fma_f32 v[250:251], v[122:123], v[4:5], v[250:251] op_sel_hi:[1,0,1]
    v_pk_fma_f32 v[252:253], v[124:125], v[4:5], v[252:253] op_sel_hi:[1,0,1]
    v_pk_fma_f32 v[254:255], v[126:127], v[4:5], v[254:255] op_sel_hi:[1,0,1]
    v_pk_fma_f32 v[192:193], v[192:193], v[2:3], v[2:3] op_sel:[0,1,1]
    v_pk_fma_f32 v[194:195], v[194:195], v[2:3], v[2:3] op_sel:[0,1,1]
    v_pk_fma_f32 v[196:197], v[196:197], v[2:3], v[2:3] op_sel:[0,1,1]
    v_pk_fma_f32 v[198:199], v[198:199], v[2:3], v[2:3] op_sel:[0,1,1]
    v_pk_fma_f32 v[200:201], v[200:201], v[2:3], v[2:3] op_sel:[0,1,1]
    v_pk_fma_f32 v[202:203], v[202:203], v[2:3], v[2:3] op_sel:[0,1,1]
    v_pk_fma_f32 v[204:205], v[204:205], v[2:3], v[2:3] op_sel:[0,1,1]
    v_pk_fma_f32 v[206:207], v[206:207], v[2:3], v[2:3] op_sel:[0,1,1]
    v_rcp_f32 v192, v192
    v_rcp_f32 v193, v193
    v_rcp_f32 v194, v194
    v_rcp_f32 v195, v195
    v_rcp_f32 v196, v196
    v_rcp_f32 v197, v197
    v_rcp_f32 v198, v198
    v_rcp_f32 v199, v199
    v_rcp_f32 v200, v200
    v_rcp_f32 v201, v201
    v_rcp_f32 v202, v202
    v_rcp_f32 v203, v203
    v_rcp_f32 v204, v204
    v_rcp_f32 v205, v205
    v_rcp_f32 v206, v206
    v_rcp_f32 v207, v207
    s_nop 0
    v_pk_mul_f32 v[192:193], v[192:193], v[240:241]
    v_pk_mul_f32 v[194:195], v[194:195], v[242:243]
    v_pk_mul_f32 v[196:197], v[196:197], v[244:245]
    v_pk_mul_f32 v[198:199], v[198:199], v[246:247]
    v_pk_mul_f32 v[200:201], v[200:201], v[248:249]
    v_pk_mul_f32 v[202:203], v[202:203], v[250:251]
    v_pk_mul_f32 v[204:205], v[204:205], v[252:253]
    v_pk_mul_f32 v[206:207], v[206:207], v[254:255]
    v_cvt_pk_bf16_f32 v240, v192, v193
    v_cvt_pk_bf16_f32 v241, v194, v195
    v_cvt_pk_bf16_f32 v242, v196, v197
    v_cvt_pk_bf16_f32 v243, v198, v199
    v_cvt_pk_bf16_f32 v244, v200, v201
    v_cvt_pk_bf16_f32 v245, v202, v203
    v_cvt_pk_bf16_f32 v246, v204, v205
    v_cvt_pk_bf16_f32 v247, v206, v207
    s_cmp_lg_u32 s36, 0
    s_cbranch_scc1 tail_sg2_d
    buffer_store_dwordx4 v[240:243], v1, s[20:23], s51 offen offset:0
    buffer_store_dwordx4 v[244:247], v1, s[20:23], s51 offen offset:1024
    s_branch tail_sg2_e
tail_sg2_d:
    buffer_store_dwordx4 v[240:243], v1, s[20:23], s51 offen offset:0 sc0 sc1
    buffer_store_dwordx4 v[244:247], v1, s[20:23], s51 offen offset:1024 sc0 sc1
tail_sg2_e:
tail_c4done:
    s_and_b32 s62, s53, 7
    s_lshl_b32 s62, s62, 4
    s_add_u32 s62, s62, s43
    s_lshl_b32 s40, s62, 2
    s_add_u32 s40, s40, s37
    v_mov_b32 v7, 0
    v_mov_b32 v5, s39
    s_mov_b64 exec, 1
    s_waitcnt vmcnt(0)
    s_cmp_lg_u32 s36, 0
    s_cbranch_scc1 tail_f3_d
    buffer_store_dword v5, v7, s[20:23], s40 offen offset:1536
    s_branch tail_f3_e
tail_f3_d:
    buffer_store_dword v5, v7, s[20:23], s40 offen offset:1536 sc0 sc1
tail_f3_e:
    s_mov_b64 exec, -1
    buffer_load_dwordx4 v[216:219], v1, s[20:23], s47 offen offset:0 sc1
    buffer_load_dwordx4 v[220:223], v1, s[20:23], s47 offen offset:1024 sc1
    v_bfe_u32 v7, v6, 2, 2
    v_lshrrev_b32 v5, 5, v6
    v_lshl_add_u32 v5, v5, 2, v7
    v_lshlrev_b32 v2, 7, v5
    v_lshrrev_b32 v7, 1, v7
    v_lshl_add_u32 v2, v7, 6, v2
    v_bfe_u32 v7, v6, 4, 1
    v_and_b32 v5, 3, v6
    v_lshl_add_u32 v7, v7, 2, v5
    v_lshl_add_u32 v2, v7, 3, v2
    s_lshl_b32 s40, s45, 11
    v_add_u32 v2, s40, v2
    v_xor_b32 v3, 64, v2
    v_and_b32 v7, 31, v6
    v_lshrrev_b32 v5, 5, v6
    v_lshlrev_b32 v4, 10, v7
    v_lshl_add_u32 v4, v5, 4, v4
    s_lshl_b32 s47, s46, 15
    s_lshl_b32 s40, s42, 7
    s_add_u32 s47, s47, s40
    s_lshl_b32 s40, s45, 6
    s_add_u32 s47, s47, s40
    s_mov_b64 s[24:25], s[18:19]
    s_mov_b32 s26, 2097152
    s_mul_i32 s49, s46, 90112
    s_lshl_b32 s40, s45, 10
    s_add_u32 s49, s49, s40
    s_add_u32 s49, s49, 11534336
    v_mov_b32 v224, 0
    v_mov_b32 v225, 0
    v_mov_b32 v226, 0
    v_mov_b32 v227, 0
    v_mov_b32 v228, 0
    v_mov_b32 v229, 0
    v_mov_b32 v230, 0
    v_mov_b32 v231, 0
    v_mov_b32 v232, 0
    v_mov_b32 v233, 0
    v_mov_b32 v234, 0
    v_mov_b32 v235, 0
    v_mov_b32 v236, 0
    v_mov_b32 v237, 0
    v_mov_b32 v238, 0
    v_mov_b32 v239, 0
    v_mov_b32 v240, 0
    v_mov_b32 v241, 0
    v_mov_b32 v242, 0
    v_mov_b32 v243, 0
    v_mov_b32 v244, 0
    v_mov_b32 v245, 0
    v_mov_b32 v246, 0
    v_mov_b32 v247, 0
    v_mov_b32 v248, 0
    v_mov_b32 v249, 0
    v_mov_b32 v250, 0
    v_mov_b32 v251, 0
    v_mov_b32 v252, 0
    v_mov_b32 v253, 0
    v_mov_b32 v254, 0
    v_mov_b32 v255, 0
    s_mov_b32 s51, 0
    s_barrier
    ds_read_b64_tr_b16 v[56:57], v2 offset:0
    ds_read_b64_tr_b16 v[58:59], v2 offset:1024
    ds_read_b64_tr_b16 v[60:61], v3 offset:0
    ds_read_b64_tr_b16 v[62:63], v3 offset:1024
    ds_read_b64_tr_b16 v[64:65], v2 offset:4096
    ds_read_b64_tr_b16 v[66:67], v2 offset:5120
    ds_read_b64_tr_b16 v[68:69], v3 offset:4096
    ds_read_b64_tr_b16 v[70:71], v3 offset:5120
    ds_read_b64_tr_b16 v[72:73], v2 offset:8192
    ds_read_b64_tr_b16 v[74:75], v2 offset:9216
    ds_read_b64_tr_b16 v[76:77], v3 offset:8192
    ds_read_b64_tr_b16 v[78:79], v3 offset:9216
    ds_read_b64_tr_b16 v[80:81], v2 offset:12288
    ds_read_b64_tr_b16 v[82:83], v2 offset:13312
    ds_read_b64_tr_b16 v[84:85], v3 offset:12288
    ds_read_b64_tr_b16 v[86:87], v3 offset:13312
    ds_read_b64_tr_b16 v[88:89], v2 offset:16384
    ds_read_b64_tr_b16 v[90:91], v2 offset:17408
    ds_read_b64_tr_b16 v[92:93], v3 offset:16384
    ds_read_b64_tr_b16 v[94:95], v3 offset:17408
    ds_read_b64_tr_b16 v[96:97], v2 offset:20480
    ds_read_b64_tr_b16 v[98:99], v2 offset:21504
    ds_read_b64_tr_b16 v[100:101], v3 offset:20480
    ds_read_b64_tr_b16 v[102:103], v3 offset:21504
    ds_read_b64_tr_b16 v[104:105], v2 offset:24576
    ds_read_b64_tr_b16 v[106:107], v2 offset:25600
    ds_read_b64_tr_b16 v[108:109], v3 offset:24576
    ds_read_b64_tr_b16 v[110:111], v3 offset:25600
    ds_read_b64_tr_b16 v[112:113], v2 offset:28672
    ds_read_b64_tr_b16 v[114:115], v2 offset:29696
    ds_read_b64_tr_b16 v[116:117], v3 offset:28672
    ds_read_b64_tr_b16 v[118:119], v3 offset:29696
    ds_read_b64_tr_b16 v[120:121], v2 offset:32768
    ds_read_b64_tr_b16 v[122:123], v2 offset:33792
    ds_read_b64_tr_b16 v[124:125], v3 offset:32768
    ds_read_b64_tr_b16 v[126:127], v3 offset:33792
    ds_read_b64_tr_b16 v[128:129], v2 offset:36864
    ds_read_b64_tr_b16 v[130:131], v2 offset:37888
    ds_read_b64_tr_b16 v[132:133], v3 offset:36864
    ds_read_b64_tr_b16 v[134:135], v3 offset:37888
    s_waitcnt lgkmcnt(0)
    s_barrier
    s_lshl_b32 s62, s61, 2
    s_add_u32 s62, s62, s37
    v_and_b32 v7, 15, v6
    v_lshlrev_b32 v7, 2, v7
    s_mov_b32 s40, 0
tail_p3:
    buffer_load_dword v140, v7, s[20:23], s62 offen offset:1536 sc1
    s_add_u32 s40, s40, 1
    s_cmp_gt_u32 s40, 200000
    s_cbranch_scc1 tail_p3_x
    s_waitcnt vmcnt(0)
    v_cmp_ne_u32 vcc, s39, v140
    s_cbranch_vccnz tail_p3
tail_p3_x:
    buffer_load_dwordx4 v[8:11], v1, s[20:23], s49 offen offset:0 sc1
    buffer_load_dwordx4 v[12:15], v1, s[20:23], s49 offen offset:2048 sc1
    s_add_u32 s49, s49, 4096
    buffer_load_dwordx4 v[16:19], v1, s[20:23], s49 offen offset:0 sc1
    buffer_load_dwordx4 v[20:23], v1, s[20:23], s49 offen offset:2048 sc1
    s_add_u32 s49, s49, 4096
    buffer_load_dwordx4 v[24:27], v1, s[20:23], s49 offen offset:0 sc1
    buffer_load_dwordx4 v[28:31], v1, s[20:23], s49 offen offset:2048 sc1
    s_add_u32 s49, s49, 4096
    buffer_load_dwordx4 v[32:35], v1, s[20:23], s49 offen offset:0 sc1
    buffer_load_dwordx4 v[36:39], v1, s[20:23], s49 offen offset:2048 sc1
    s_add_u32 s49, s49, 4096
    buffer_load_dwordx4 v[40:43], v1, s[20:23], s49 offen offset:0 sc1
.p2align 6
tail_c5:
    v_add_u32 v2, 40960, v2
    v_add_u32 v3, 40960, v3
    s_waitcnt lgkmcnt(0)
    s_cmp_lg_u32 s51, 2
    s_cbranch_scc1 tail_c5n
    s_barrier
tail_c5n:
    s_waitcnt vmcnt(8)
    v_mfma_f32_32x32x16_bf16 v[224:239], v[56:59], v[8:11], v[224:239]
    buffer_load_dwordx4 v[44:47], v1, s[20:23], s49 offen offset:2048 sc1
    s_add_u32 s49, s49, 4096
    v_mfma_f32_32x32x16_bf16 v[240:255], v[60:63], v[8:11], v[240:255]
    ds_read_b64_tr_b16 v[56:57], v2 offset:0
    ds_read_b64_tr_b16 v[58:59], v2 offset:1024
    ds_read_b64_tr_b16 v[60:61], v3 offset:0
    ds_read_b64_tr_b16 v[62:63], v3 offset:1024
    s_waitcnt vmcnt(8)
    v_mfma_f32_32x32x16_bf16 v[224:239], v[64:67], v[12:15], v[224:239]
    buffer_load_dwordx4 v[8:11], v1, s[20:23], s49 offen offset:0 sc1
    v_mfma_f32_32x32x16_bf16 v[240:255], v[68:71], v[12:15], v[240:255]
    ds_read_b64_tr_b16 v[64:65], v2 offset:4096
    ds_read_b64_tr_b16 v[66:67], v2 offset:5120
    ds_read_b64_tr_b16 v[68:69], v3 offset:4096
    ds_read_b64_tr_b16 v[70:71], v3 offset:5120
    s_waitcnt vmcnt(8)
    v_mfma_f32_32x32x16_bf16 v[224:239], v[72:75], v[16:19], v[224:239]
    buffer_load_dwordx4 v[12:15], v1, s[20:23], s49 offen offset:2048 sc1
    s_add_u32 s49, s49, 4096
    v_mfma_f32_32x32x16_bf16 v[240:255], v[76:79], v[16:19], v[240:255]
    ds_read_b64_tr_b16 v[72:73], v2 offset:8192
    ds_read_b64_tr_b16 v[74:75], v2 offset:9216
    ds_read_b64_tr_b16 v[76:77], v3 offset:8192
    ds_read_b64_tr_b16 v[78:79], v3 offset:9216
    s_waitcnt vmcnt(8)
    v_mfma_f32_32x32x16_bf16 v[224:239], v[80:83], v[20:23], v[224:239]
    buffer_load_dwordx4 v[16:19], v1, s[20:23], s49 offen offset:0 sc1
    v_mfma_f32_32x32x16_bf16 v[240:255], v[84:87], v[20:23], v[240:255]
    ds_read_b64_tr_b16 v[80:81], v2 offset:12288
    ds_read_b64_tr_b16 v[82:83], v2 offset:13312
    ds_read_b64_tr_b16 v[84:85], v3 offset:12288
    ds_read_b64_tr_b16 v[86:87], v3 offset:13312
    s_waitcnt vmcnt(8)
    v_mfma_f32_32x32x16_bf16 v[224:239], v[88:91], v[24:27], v[224:239]
    buffer_load_dwordx4 v[20:23], v1, s[20:23], s49 offen offset:2048 sc1
    s_add_u32 s49, s49, 4096
    v_mfma_f32_32x32x16_bf16 v[240:255], v[92:95], v[24:27], v[240:255]
    ds_read_b64_tr_b16 v[88:89], v2 offset:16384
    ds_read_b64_tr_b16 v[90:91], v2 offset:17408
    ds_read_b64_tr_b16 v[92:93], v3 offset:16384
    ds_read_b64_tr_b16 v[94:95], v3 offset:17408
    s_waitcnt vmcnt(8)
    v_mfma_f32_32x32x16_bf16 v[224:239], v[96:99], v[28:31], v[224:239]
    buffer_load_dwordx4 v[24:27], v1, s[20:23], s49 offen offset:0 sc1
    v_mfma_f32_32x32x16_bf16 v[240:255], v[100:103], v[28:31], v[240:255]
    ds_read_b64_tr_b16 v[96:97], v2 offset:20480
    ds_read_b64_tr_b16 v[98:99], v2 offset:21504
    ds_read_b64_tr_b16 v[100:101], v3 offset:20480
    ds_read_b64_tr_b16 v[102:103], v3 offset:21504
    s_waitcnt vmcnt(8)
    v_mfma_f32_32x32x16_bf16 v[224:239], v[104:107], v[32:35], v[224:239]
    buffer_load_dwordx4 v[28:31], v1, s[20:23], s49 offen offset:2048 sc1
    s_add_u32 s49, s49, 4096
    v_mfma_f32_32x32x16_bf16 v[240:255], v[108:111], v[32:35], v[240:255]
    ds_read_b64_tr_b16 v[104:105], v2 offset:24576
    ds_read_b64_tr_b16 v[106:107], v2 offset:25600
    ds_read_b64_tr_b16 v[108:109], v3 offset:24576
    ds_read_b64_tr_b16 v[110:111], v3 offset:25600
    s_waitcnt vmcnt(8)
    v_mfma_f32_32x32x16_bf16 v[224:239], v[112:115], v[36:39], v[224:239]
    buffer_load_dwordx4 v[32:35], v1, s[20:23], s49 offen offset:0 sc1
    v_mfma_f32_32x32x16_bf16 v[240:255], v[116:119], v[36:39], v[240:255]
    ds_read_b64_tr_b16 v[112:113], v2 offset:28672
    ds_read_b64_tr_b16 v[114:115], v2 offset:29696
    ds_read_b64_tr_b16 v[116:117], v3 offset:28672
    ds_read_b64_tr_b16 v[118:119], v3 offset:29696
    s_waitcnt vmcnt(8)
    v_mfma_f32_32x32x16_bf16 v[224:239], v[120:123], v[40:43], v[224:239]
    buffer_load_dwordx4 v[36:39], v1, s[20:23], s49 offen offset:2048 sc1
    s_add_u32 s49, s49, 4096
    v_mfma_f32_32x32x16_bf16 v[240:255], v[124:127], v[40:43], v[240:255]
    ds_read_b64_tr_b16 v[120:121], v2 offset:32768
    ds_read_b64_tr_b16 v[122:123], v2 offset:33792
    ds_read_b64_tr_b16 v[124:125], v3 offset:32768
    ds_read_b64_tr_b16 v[126:127], v3 offset:33792
    s_waitcnt vmcnt(8)
    v_mfma_f32_32x32x16_bf16 v[224:239], v[128:131], v[44:47], v[224:239]
    buffer_load_dwordx4 v[40:43], v1, s[20:23], s49 offen offset:0 sc1
    v_mfma_f32_32x32x16_bf16 v[240:255], v[132:135], v[44:47], v[240:255]
    ds_read_b64_tr_b16 v[128:129], v2 offset:36864
    ds_read_b64_tr_b16 v[130:131], v2 offset:37888
    ds_read_b64_tr_b16 v[132:133], v3 offset:36864
    ds_read_b64_tr_b16 v[134:135], v3 offset:37888
    s_add_u32 s51, s51, 1
    s_cmp_lt_u32 s51, 3
    s_cbranch_scc1 tail_c5
    v_add_u32 v2, 0xfffe2000, v2
    v_add_u32 v3, 0xfffe2000, v3
    s_waitcnt lgkmcnt(0)
    s_waitcnt vmcnt(8)
    v_mfma_f32_32x32x16_bf16 v[224:239], v[56:59], v[8:11], v[224:239]
    buffer_load_dwordx4 v[44:47], v1, s[20:23], s49 offen offset:2048 sc1
    s_add_u32 s49, s49, 4096
    v_mfma_f32_32x32x16_bf16 v[240:255], v[60:63], v[8:11], v[240:255]
    ds_read_b64_tr_b16 v[56:57], v2 offset:0
    ds_read_b64_tr_b16 v[58:59], v2 offset:1024
    ds_read_b64_tr_b16 v[60:61], v3 offset:0
    ds_read_b64_tr_b16 v[62:63], v3 offset:1024
    s_waitcnt vmcnt(8)
    v_mfma_f32_32x32x16_bf16 v[224:239], v[64:67], v[12:15], v[224:239]
    buffer_load_dwordx4 v[8:11], v1, s[20:23], s49 offen offset:0 sc1
    v_mfma_f32_32x32x16_bf16 v[240:255], v[68:71], v[12:15], v[240:255]
    ds_read_b64_tr_b16 v[64:65], v2 offset:4096
    ds_read_b64_tr_b16 v[66:67], v2 offset:5120
    ds_read_b64_tr_b16 v[68:69], v3 offset:4096
    ds_read_b64_tr_b16 v[70:71], v3 offset:5120
    s_waitcnt vmcnt(8)
    v_mfma_f32_32x32x16_bf16 v[224:239], v[72:75], v[16:19], v[224:239]
    buffer_load_dwordx4 v[12:15], v1, s[20:23], s49 offen offset:2048 sc1
    s_add_u32 s49, s49, 4096
    v_mfma_f32_32x32x16_bf16 v[240:255], v[76:79], v[16:19], v[240:255]
    ds_read_b64_tr_b16 v[72:73], v2 offset:8192
    ds_read_b64_tr_b16 v[74:75], v2 offset:9216
    ds_read_b64_tr_b16 v[76:77], v3 offset:8192
    ds_read_b64_tr_b16 v[78:79], v3 offset:9216
    s_waitcnt vmcnt(8)
    v_mfma_f32_32x32x16_bf16 v[224:239], v[80:83], v[20:23], v[224:239]
    buffer_load_dwordx4 v[16:19], v1, s[20:23], s49 offen offset:0 sc1
    v_mfma_f32_32x32x16_bf16 v[240:255], v[84:87], v[20:23], v[240:255]
    ds_read_b64_tr_b16 v[80:81], v2 offset:12288
    ds_read_b64_tr_b16 v[82:83], v2 offset:13312
    ds_read_b64_tr_b16 v[84:85], v3 offset:12288
    ds_read_b64_tr_b16 v[86:87], v3 offset:13312
    s_waitcnt vmcnt(8)
    v_mfma_f32_32x32x16_bf16 v[224:239], v[88:91], v[24:27], v[224:239]
    buffer_load_dwordx4 v[20:23], v1, s[20:23], s49 offen offset:2048 sc1
    s_add_u32 s49, s49, 4096
    v_mfma_f32_32x32x16_bf16 v[240:255], v[92:95], v[24:27], v[240:255]
    s_waitcnt vmcnt(8)
    v_mfma_f32_32x32x16_bf16 v[224:239], v[96:99], v[28:31], v[224:239]
    v_mfma_f32_32x32x16_bf16 v[240:255], v[100:103], v[28:31], v[240:255]
    s_waitcnt vmcnt(7)
    v_mfma_f32_32x32x16_bf16 v[224:239], v[104:107], v[32:35], v[224:239]
    v_mfma_f32_32x32x16_bf16 v[240:255], v[108:111], v[32:35], v[240:255]
    s_waitcnt vmcnt(6)
    v_mfma_f32_32x32x16_bf16 v[224:239], v[112:115], v[36:39], v[224:239]
    v_mfma_f32_32x32x16_bf16 v[240:255], v[116:119], v[36:39], v[240:255]
    s_waitcnt vmcnt(5)
    v_mfma_f32_32x32x16_bf16 v[224:239], v[120:123], v[40:43], v[224:239]
    v_mfma_f32_32x32x16_bf16 v[240:255], v[124:127], v[40:43], v[240:255]
    s_waitcnt vmcnt(4)
    v_mfma_f32_32x32x16_bf16 v[224:239], v[128:131], v[44:47], v[224:239]
    v_mfma_f32_32x32x16_bf16 v[240:255], v[132:135], v[44:47], v[240:255]
    s_waitcnt lgkmcnt(0)
    s_waitcnt vmcnt(3)
    v_mfma_f32_32x32x16_bf16 v[224:239], v[56:59], v[8:11], v[224:239]
    v_mfma_f32_32x32x16_bf16 v[240:255], v[60:63], v[8:11], v[240:255]
    s_waitcnt vmcnt(2)
    v_mfma_f32_32x32x16_bf16 v[224:239], v[64:67], v[12:15], v[224:239]
    v_mfma_f32_32x32x16_bf16 v[240:255], v[68:71], v[12:15], v[240:255]
    s_waitcnt vmcnt(1)
    v_mfma_f32_32x32x16_bf16 v[224:239], v[72:75], v[16:19], v[224:239]
    v_mfma_f32_32x32x16_bf16 v[240:255], v[76:79], v[16:19], v[240:255]
    s_waitcnt vmcnt(0)
    v_mfma_f32_32x32x16_bf16 v[224:239], v[80:83], v[20:23], v[224:239]
    v_mfma_f32_32x32x16_bf16 v[240:255], v[84:87], v[20:23], v[240:255]
    s_xor_b32 s40, s33, 2
    s_lshl_b32 s40, s40, 12
    s_add_u32 s40, s40, 16384
    v_add_u32 v7, s40, v1
    s_lshl_b32 s40, s33, 12
    s_add_u32 s40, s40, 16384
    v_add_u32 v5, s40, v1
    s_nop 4
    s_cmp_eq_u32 s45, 0
    s_cbranch_scc1 tail_x50
    ds_write_b128 v7, v[224:227] offset:0
    ds_write_b128 v7, v[228:231] offset:1024
    ds_write_b128 v7, v[232:235] offset:2048
    ds_write_b128 v7, v[236:239] offset:3072
    s_waitcnt lgkmcnt(0)
    v_pk_mov_b32 v[224:225], v[240:241], v[240:241] op_sel:[0,1]
    v_pk_mov_b32 v[226:227], v[242:243], v[242:243] op_sel:[0,1]
    v_pk_mov_b32 v[228:229], v[244:245], v[244:245] op_sel:[0,1]
    v_pk_mov_b32 v[230:231], v[246:247], v[246:247] op_sel:[0,1]
    v_pk_mov_b32 v[232:233], v[248:249], v[248:249] op_sel:[0,1]
    v_pk_mov_b32 v[234:235], v[250:251], v[250:251] op_sel:[0,1]
    v_pk_mov_b32 v[236:237], v[252:253], v[252:253] op_sel:[0,1]
    v_pk_mov_b32 v[238:239], v[254:255], v[254:255] op_sel:[0,1]
    s_branch tail_x51
tail_x50:
    ds_write_b128 v7, v[240:243] offset:0
    ds_write_b128 v7, v[244:247] offset:1024
    ds_write_b128 v7, v[248:251] offset:2048
    ds_write_b128 v7, v[252:255] offset:3072
    s_waitcnt lgkmcnt(0)
tail_x51:
    s_barrier
    ds_read_b128 v[240:243], v5 offset:0
    ds_read_b128 v[244:247], v5 offset:1024
    ds_read_b128 v[248:251], v5 offset:2048
    ds_read_b128 v[252:255], v5 offset:3072
    v_lshlrev_b32 v144, 16, v216
    v_and_b32 v145, 0xffff0000, v216
    v_lshlrev_b32 v146, 16, v217
    v_and_b32 v147, 0xffff0000, v217
    v_lshlrev_b32 v148, 16, v218
    v_and_b32 v149, 0xffff0000, v218
    v_lshlrev_b32 v150, 16, v219
    v_and_b32 v151, 0xffff0000, v219
    v_lshlrev_b32 v152, 16, v220
    v_and_b32 v153, 0xffff0000, v220
    v_lshlrev_b32 v154, 16, v221
    v_and_b32 v155, 0xffff0000, v221
    v_lshlrev_b32 v156, 16, v222
    v_and_b32 v157, 0xffff0000, v222
    v_lshlrev_b32 v158, 16, v223
    v_and_b32 v159, 0xffff0000, v223
    v_pk_add_f32 v[144:145], v[144:145], v[224:225]
    v_pk_add_f32 v[146:147], v[146:147], v[226:227]
    v_pk_add_f32 v[148:149], v[148:149], v[228:229]
    v_pk_add_f32 v[150:151], v[150:151], v[230:231]
    v_pk_add_f32 v[152:153], v[152:153], v[232:233]
    v_pk_add_f32 v[154:155], v[154:155], v[234:235]
    v_pk_add_f32 v[156:157], v[156:157], v[236:237]
    v_pk_add_f32 v[158:159], v[158:159], v[238:239]
    s_waitcnt lgkmcnt(0)
    v_pk_add_f32 v[144:145], v[144:145], v[240:241]
    v_pk_add_f32 v[146:147], v[146:147], v[242:243]
    v_pk_add_f32 v[148:149], v[148:149], v[244:245]
    v_pk_add_f32 v[150:151], v[150:151], v[246:247]
    v_pk_add_f32 v[152:153], v[152:153], v[248:249]
    v_pk_add_f32 v[154:155], v[154:155], v[250:251]
    v_pk_add_f32 v[156:157], v[156:157], v[252:253]
    v_pk_add_f32 v[158:159], v[158:159], v[254:255]
    v_cvt_pk_bf16_f32 v216, v144, v145
    v_cvt_pk_bf16_f32 v217, v146, v147
    v_cvt_pk_bf16_f32 v218, v148, v149
    v_cvt_pk_bf16_f32 v219, v150, v151
    v_cvt_pk_bf16_f32 v220, v152, v153
    v_cvt_pk_bf16_f32 v221, v154, v155
    v_cvt_pk_bf16_f32 v222, v156, v157
    v_cvt_pk_bf16_f32 v223, v158, v159
    s_nop 1
    v_permlane32_swap_b32 v216, v218
    v_permlane32_swap_b32 v217, v219
    v_permlane32_swap_b32 v220, v222
    v_permlane32_swap_b32 v221, v223
    buffer_store_dwordx4 v[216:219], v4, s[24:27], s47 offen offset:0
    buffer_store_dwordx4 v[220:223], v4, s[24:27], s47 offen offset:32
    s_endpgm
.p2align 6
tail_aloop:
    v_mfma_f32_32x32x16_bf16 v[60:75], v[16:19], v[12:15], 0
    ds_read_b128 v[16:19], v2 offset:4096
    v_exp_f32 v44, v44
    v_exp_f32 v45, v45
    v_exp_f32 v46, v46
    v_exp_f32 v47, v47
    v_exp_f32 v48, v48
    v_exp_f32 v49, v49
    v_mfma_f32_32x32x16_bf16 v[92:107], v[32:35], v[40:43], v[92:107]
    ds_read_b64_tr_b16 v[28:29], v3 offset:4096
    ds_read_b64_tr_b16 v[30:31], v3 offset:4224
    ds_read_b64_tr_b16 v[32:33], v3 offset:4352
    ds_read_b64_tr_b16 v[34:35], v3 offset:4480
    v_exp_f32 v50, v50
    v_exp_f32 v51, v51
    v_cvt_pk_bf16_f32 v36, v44, v45
    v_cvt_pk_bf16_f32 v37, v46, v47
    v_cvt_pk_bf16_f32 v38, v48, v49
    v_cvt_pk_bf16_f32 v39, v50, v51
    v_exp_f32 v52, v52
    v_exp_f32 v53, v53
    v_exp_f32 v54, v54
    s_waitcnt lgkmcnt(5)
    v_mfma_f32_32x32x16_bf16 v[76:91], v[20:23], v[36:39], v[76:91]
    v_exp_f32 v55, v55
    v_exp_f32 v56, v56
    v_exp_f32 v57, v57
    v_exp_f32 v58, v58
    v_exp_f32 v59, v59
    v_cvt_pk_bf16_f32 v40, v52, v53
    v_cvt_pk_bf16_f32 v41, v54, v55
    v_cvt_pk_bf16_f32 v42, v56, v57
    v_cvt_pk_bf16_f32 v43, v58, v59
    s_waitcnt lgkmcnt(4)
    v_mfma_f32_32x32x16_bf16 v[44:59], v[16:19], v[8:11], 0
    v_exp_f32 v60, v60
    v_exp_f32 v61, v61
    v_exp_f32 v62, v62
    v_exp_f32 v63, v63
    v_exp_f32 v64, v64
    v_exp_f32 v65, v65
    v_mfma_f32_32x32x16_bf16 v[76:91], v[24:27], v[40:43], v[76:91]
    s_setprio 2
    v_exp_f32 v66, v66
    v_exp_f32 v67, v67
    v_cvt_pk_bf16_f32 v36, v60, v61
    v_cvt_pk_bf16_f32 v37, v62, v63
    v_cvt_pk_bf16_f32 v38, v64, v65
    v_cvt_pk_bf16_f32 v39, v66, v67
    v_exp_f32 v68, v68
    v_exp_f32 v69, v69
    v_exp_f32 v70, v70
    v_mfma_f32_32x32x16_bf16 v[92:107], v[20:23], v[36:39], v[92:107]
    v_exp_f32 v71, v71
    v_exp_f32 v72, v72
    v_exp_f32 v73, v73
    v_exp_f32 v74, v74
    v_exp_f32 v75, v75
    v_cvt_pk_bf16_f32 v40, v68, v69
    v_cvt_pk_bf16_f32 v41, v70, v71
    v_cvt_pk_bf16_f32 v42, v72, v73
    v_cvt_pk_bf16_f32 v43, v74, v75
    v_mfma_f32_32x32x16_bf16 v[60:75], v[16:19], v[12:15], 0
    ds_read_b128 v[16:19], v2 offset:8192
    v_exp_f32 v44, v44
    v_exp_f32 v45, v45
    v_exp_f32 v46, v46
    v_exp_f32 v47, v47
    v_exp_f32 v48, v48
    v_exp_f32 v49, v49
    v_mfma_f32_32x32x16_bf16 v[92:107], v[24:27], v[40:43], v[92:107]
    ds_read_b64_tr_b16 v[20:21], v3 offset:8192
    ds_read_b64_tr_b16 v[22:23], v3 offset:8320
    ds_read_b64_tr_b16 v[24:25], v3 offset:8448
    ds_read_b64_tr_b16 v[26:27], v3 offset:8576
    v_exp_f32 v50, v50
    v_exp_f32 v51, v51
    v_cvt_pk_bf16_f32 v36, v44, v45
    v_cvt_pk_bf16_f32 v37, v46, v47
    v_cvt_pk_bf16_f32 v38, v48, v49
    v_cvt_pk_bf16_f32 v39, v50, v51
    v_exp_f32 v52, v52
    v_exp_f32 v53, v53
    v_exp_f32 v54, v54
    s_waitcnt lgkmcnt(5)
    v_mfma_f32_32x32x16_bf16 v[76:91], v[28:31], v[36:39], v[76:91]
    v_exp_f32 v55, v55
    v_exp_f32 v56, v56
    v_exp_f32 v57, v57
    v_exp_f32 v58, v58
    v_exp_f32 v59, v59
    v_cvt_pk_bf16_f32 v40, v52, v53
    v_cvt_pk_bf16_f32 v41, v54, v55
    v_cvt_pk_bf16_f32 v42, v56, v57
    v_cvt_pk_bf16_f32 v43, v58, v59
    s_waitcnt lgkmcnt(4)
    v_mfma_f32_32x32x16_bf16 v[44:59], v[16:19], v[8:11], 0
    v_exp_f32 v60, v60
    v_exp_f32 v61, v61
    v_exp_f32 v62, v62
    v_exp_f32 v63, v63
    v_exp_f32 v64, v64
    v_exp_f32 v65, v65
    v_mfma_f32_32x32x16_bf16 v[76:91], v[32:35], v[40:43], v[76:91]
    s_setprio 1
    v_exp_f32 v66, v66
    v_exp_f32 v67, v67
    v_cvt_pk_bf16_f32 v36, v60, v61
    v_cvt_pk_bf16_f32 v37, v62, v63
    v_cvt_pk_bf16_f32 v38, v64, v65
    v_cvt_pk_bf16_f32 v39, v66, v67
    v_exp_f32 v68, v68
    v_exp_f32 v69, v69
    v_exp_f32 v70, v70
    v_mfma_f32_32x32x16_bf16 v[92:107], v[28:31], v[36:39], v[92:107]
    v_exp_f32 v71, v71
    v_exp_f32 v72, v72
    v_exp_f32 v73, v73
    v_exp_f32 v74, v74
    v_exp_f32 v75, v75
    v_add_u32 v3, v4, v3
    v_cvt_pk_bf16_f32 v40, v68, v69
    v_cvt_pk_bf16_f32 v41, v70, v71
    v_cvt_pk_bf16_f32 v42, v72, v73
    v_cvt_pk_bf16_f32 v43, v74, v75
    v_mfma_f32_32x32x16_bf16 v[60:75], v[16:19], v[12:15], 0
    ds_read_b128 v[16:19], v2 offset:12288
    v_exp_f32 v44, v44
    v_exp_f32 v45, v45
    v_exp_f32 v46, v46
    v_exp_f32 v47, v47
    v_exp_f32 v48, v48
    v_exp_f32 v49, v49
    v_mfma_f32_32x32x16_bf16 v[92:107], v[32:35], v[40:43], v[92:107]
    ds_read_b64_tr_b16 v[28:29], v3 offset:4096
    ds_read_b64_tr_b16 v[30:31], v3 offset:4224
    ds_read_b64_tr_b16 v[32:33], v3 offset:4352
    ds_read_b64_tr_b16 v[34:35], v3 offset:4480
    v_exp_f32 v50, v50
    v_exp_f32 v51, v51
    v_cvt_pk_bf16_f32 v36, v44, v45
    v_cvt_pk_bf16_f32 v37, v46, v47
    v_cvt_pk_bf16_f32 v38, v48, v49
    v_cvt_pk_bf16_f32 v39, v50, v51
    v_exp_f32 v52, v52
    v_exp_f32 v53, v53
    v_exp_f32 v54, v54
    s_waitcnt lgkmcnt(5)
    v_mfma_f32_32x32x16_bf16 v[76:91], v[20:23], v[36:39], v[76:91]
    v_exp_f32 v55, v55
    v_exp_f32 v56, v56
    v_exp_f32 v57, v57
    v_exp_f32 v58, v58
    v_exp_f32 v59, v59
    v_cvt_pk_bf16_f32 v40, v52, v53
    v_cvt_pk_bf16_f32 v41, v54, v55
    v_cvt_pk_bf16_f32 v42, v56, v57
    v_cvt_pk_bf16_f32 v43, v58, v59
    s_waitcnt lgkmcnt(4)
    v_mfma_f32_32x32x16_bf16 v[44:59], v[16:19], v[8:11], 0
    v_exp_f32 v60, v60
    v_exp_f32 v61, v61
    v_exp_f32 v62, v62
    v_exp_f32 v63, v63
    v_exp_f32 v64, v64
    v_exp_f32 v65, v65
    v_mfma_f32_32x32x16_bf16 v[76:91], v[24:27], v[40:43], v[76:91]
    s_setprio 0
    v_exp_f32 v66, v66
    v_exp_f32 v67, v67
    v_cvt_pk_bf16_f32 v36, v60, v61
    v_cvt_pk_bf16_f32 v37, v62, v63
    v_cvt_pk_bf16_f32 v38, v64, v65
    v_cvt_pk_bf16_f32 v39, v66, v67
    v_exp_f32 v68, v68
    v_exp_f32 v69, v69
    v_exp_f32 v70, v70
    v_mfma_f32_32x32x16_bf16 v[92:107], v[20:23], v[36:39], v[92:107]
    v_exp_f32 v71, v71
    v_exp_f32 v72, v72
    v_exp_f32 v73, v73
    v_exp_f32 v74, v74
    v_exp_f32 v75, v75
    v_cvt_pk_bf16_f32 v40, v68, v69
    v_cvt_pk_bf16_f32 v41, v70, v71
    v_cvt_pk_bf16_f32 v42, v72, v73
    v_cvt_pk_bf16_f32 v43, v74, v75
    v_mfma_f32_32x32x16_bf16 v[60:75], v[16:19], v[12:15], 0
    ds_read_b128 v[16:19], v2 offset:16384
    v_exp_f32 v44, v44
    v_exp_f32 v45, v45
    v_exp_f32 v46, v46
    v_exp_f32 v47, v47
    v_exp_f32 v48, v48
    v_exp_f32 v49, v49
    v_mfma_f32_32x32x16_bf16 v[92:107], v[24:27], v[40:43], v[92:107]
    ds_read_b64_tr_b16 v[20:21], v3 offset:8192
    ds_read_b64_tr_b16 v[22:23], v3 offset:8320
    ds_read_b64_tr_b16 v[24:25], v3 offset:8448
    ds_read_b64_tr_b16 v[26:27], v3 offset:8576
    v_exp_f32 v50, v50
    v_exp_f32 v51, v51
    v_cvt_pk_bf16_f32 v36, v44, v45
    v_cvt_pk_bf16_f32 v37, v46, v47
    v_cvt_pk_bf16_f32 v38, v48, v49
    v_cvt_pk_bf16_f32 v39, v50, v51
    v_exp_f32 v52, v52
    v_exp_f32 v53, v53
    v_exp_f32 v54, v54
    s_waitcnt lgkmcnt(5)
    v_mfma_f32_32x32x16_bf16 v[76:91], v[28:31], v[36:39], v[76:91]
    v_exp_f32 v55, v55
    v_exp_f32 v56, v56
    v_exp_f32 v57, v57
    v_exp_f32 v58, v58
    v_exp_f32 v59, v59
    v_cvt_pk_bf16_f32 v40, v52, v53
    v_cvt_pk_bf16_f32 v41, v54, v55
    v_cvt_pk_bf16_f32 v42, v56, v57
    v_cvt_pk_bf16_f32 v43, v58, v59
    s_waitcnt lgkmcnt(4)
    v_mfma_f32_32x32x16_bf16 v[44:59], v[16:19], v[8:11], 0
    v_exp_f32 v60, v60
    v_exp_f32 v61, v61
    v_exp_f32 v62, v62
    v_exp_f32 v63, v63
    v_exp_f32 v64, v64
    v_exp_f32 v65, v65
    v_mfma_f32_32x32x16_bf16 v[76:91], v[32:35], v[40:43], v[76:91]
    s_setprio 3
    v_exp_f32 v66, v66
    v_exp_f32 v67, v67
    v_cvt_pk_bf16_f32 v36, v60, v61
    v_cvt_pk_bf16_f32 v37, v62, v63
    v_cvt_pk_bf16_f32 v38, v64, v65
    v_cvt_pk_bf16_f32 v39, v66, v67
    v_exp_f32 v68, v68
    v_exp_f32 v69, v69
    v_exp_f32 v70, v70
    v_mfma_f32_32x32x16_bf16 v[92:107], v[28:31], v[36:39], v[92:107]
    v_exp_f32 v71, v71
    v_exp_f32 v72, v72
    v_exp_f32 v73, v73
    v_exp_f32 v74, v74
    v_exp_f32 v75, v75
    v_add_u32 v2, 16384, v2
    v_add_u32 v3, v4, v3
    v_cvt_pk_bf16_f32 v40, v68, v69
    v_cvt_pk_bf16_f32 v41, v70, v71
    v_cvt_pk_bf16_f32 v42, v72, v73
    v_cvt_pk_bf16_f32 v43, v74, v75
    s_setpc_b64 s[66:67]
tail_slow:
    v_mov_b32 v7, 0xff800000
    s_add_u32 s44, s41, 2097152
    s_mov_b32 s40, 0
tail_maxloop:
    buffer_load_dwordx4 v[16:19], v1, s[20:23], s44 offen sc1
    s_add_u32 s44, s44, 1024
    s_waitcnt vmcnt(0)
    v_mfma_f32_32x32x16_bf16 v[44:59], v[16:19], v[8:11], 0
    s_add_u32 s40, s40, 1
    s_nop 15
    v_max3_f32 v7, v44, v45, v7
    v_max3_f32 v7, v46, v47, v7
    v_max3_f32 v7, v48, v49, v7
    v_max3_f32 v7, v50, v51, v7
    v_max3_f32 v7, v52, v53, v7
    v_max3_f32 v7, v54, v55, v7
    v_max3_f32 v7, v56, v57, v7
    v_max3_f32 v7, v58, v59, v7
    s_cmp_lt_u32 s40, 64
    s_cbranch_scc1 tail_maxloop
    v_mov_b32 v5, v7
    s_nop 1
    v_permlane32_swap_b32 v7, v5
    s_nop 1
    v_max_f32 v7, v7, v5
    v_sub_f32 v60, 0, v7
    v_mov_b32 v76, 0
    v_sub_f32 v61, 0, v7
    v_mov_b32 v77, 0
    v_sub_f32 v62, 0, v7
    v_mov_b32 v78, 0
    v_sub_f32 v63, 0, v7
    v_mov_b32 v79, 0
    v_sub_f32 v64, 0, v7
    v_mov_b32 v80, 0
    v_sub_f32 v65, 0, v7
    v_mov_b32 v81, 0
    v_sub_f32 v66, 0, v7
    v_mov_b32 v82, 0
    v_sub_f32 v67, 0, v7
    v_mov_b32 v83, 0
    v_sub_f32 v68, 0, v7
    v_mov_b32 v84, 0
    v_sub_f32 v69, 0, v7
    v_mov_b32 v85, 0
    v_sub_f32 v70, 0, v7
    v_mov_b32 v86, 0
    v_sub_f32 v71, 0, v7
    v_mov_b32 v87, 0
    v_sub_f32 v72, 0, v7
    v_mov_b32 v88, 0
    v_sub_f32 v73, 0, v7
    v_mov_b32 v89, 0
    v_sub_f32 v74, 0, v7
    v_mov_b32 v90, 0
    v_sub_f32 v75, 0, v7
    v_mov_b32 v91, 0
    s_mov_b32 s45, s43
    v_add_u32 v3, s45, v110
    v_and_b32 v7, 15, v6
    v_lshlrev_b32 v7, 3, v7
    v_add_u32 v7, 131200, v7
    v_cndmask_b32 v3, v7, v3, s[50:51]
    v_lshrrev_b32 v7, 5, v6
    v_lshlrev_b32 v7, 6, v7
    v_xor_b32 v108, v7, v1
    s_mov_b32 m0, s45
    s_add_u32 s44, s41, 2097152
    s_mov_b32 s40, 0
tail_sloop:
    s_add_u32 s45, s44, 2097152
    buffer_load_dwordx4 v[16:19], v1, s[20:23], s44 offen sc1
    buffer_load_dwordx4 v108, s[20:23], s45 offen sc1 lds
    s_add_u32 s44, s44, 1024
    s_waitcnt vmcnt(0)
    v_mfma_f32_32x32x16_bf16 v[44:59], v[16:19], v[8:11], v[60:75]
    ds_read_b64_tr_b16 v[20:21], v3 offset:0
    ds_read_b64_tr_b16 v[22:23], v3 offset:128
    ds_read_b64_tr_b16 v[24:25], v3 offset:256
    ds_read_b64_tr_b16 v[26:27], v3 offset:384
    s_add_u32 s40, s40, 1
    s_nop 15
    v_exp_f32 v44, v44
    v_exp_f32 v45, v45
    v_exp_f32 v46, v46
    v_exp_f32 v47, v47
    v_exp_f32 v48, v48
    v_exp_f32 v49, v49
    v_exp_f32 v50, v50
    v_exp_f32 v51, v51
    v_exp_f32 v52, v52
    v_exp_f32 v53, v53
    v_exp_f32 v54, v54
    v_exp_f32 v55, v55
    v_exp_f32 v56, v56
    v_exp_f32 v57, v57
    v_exp_f32 v58, v58
    v_exp_f32 v59, v59
    v_cvt_pk_bf16_f32 v36, v44, v45
    v_cvt_pk_bf16_f32 v37, v46, v47
    v_cvt_pk_bf16_f32 v38, v48, v49
    v_cvt_pk_bf16_f32 v39, v50, v51
    v_cvt_pk_bf16_f32 v40, v52, v53
    v_cvt_pk_bf16_f32 v41, v54, v55
    v_cvt_pk_bf16_f32 v42, v56, v57
    v_cvt_pk_bf16_f32 v43, v58, v59
    s_waitcnt lgkmcnt(0)
    s_cmp_lt_u32 s40, 64
    v_mfma_f32_32x32x16_bf16 v[76:91], v[20:23], v[36:39], v[76:91]
    v_mfma_f32_32x32x16_bf16 v[76:91], v[24:27], v[40:43], v[76:91]
    s_cbranch_scc1 tail_sloop
    s_nop 15
    s_branch tail_fin
tail_end:
    s_endpgm
code_end:
.section .rodata,"a"
.p2align 6
.amdhsa_kernel sequential_preLN__mha_block__glu_gated_glu__prompt_kernel
  .amdhsa_next_free_vgpr 256
  .amdhsa_next_free_sgpr 102
  .amdhsa_accum_offset 256
  .amdhsa_group_segment_fixed_size 0
  .amdhsa_kernarg_size 80
  .amdhsa_user_sgpr_count 2
  .amdhsa_user_sgpr_kernarg_segment_ptr 1
  .amdhsa_system_sgpr_workgroup_id_x 1
  .amdhsa_float_denorm_mode_32 3
  .amdhsa_float_denorm_mode_16_64 3
.end_amdhsa_kernel
```
